```python
import torch

def _softmax(x, axis=-1):
    return torch.softmax(x, dim=axis)

def _gelu(x):
    return torch.nn.functional.gelu(x, approximate='tanh')

def _silu(x):
    return torch.nn.functional.silu(x)

def _sigmoid(x):
    return torch.sigmoid(x)

def _layernorm(x, axis=-1, eps=1e-05):
    m = x.mean(dim=axis, keepdim=True)
    v = x.var(dim=axis, keepdim=True, unbiased=False)
    return (x - m) / torch.sqrt(v + eps)

def _scatter_add(tgt, idx, src, axis=0):
    return tgt.clone().index_add_(axis, idx, src)

def _segment_sum(src, seg, n):
    out = torch.zeros((n,) + src.shape[1:], dtype=src.dtype)
    return out.index_add_(0, seg, src)

def _pad(x, pw):
    flat = tuple((v for pair in reversed(pw) for v in pair))
    return torch.nn.functional.pad(x, flat)
kernel_name = 'adaLN_cond__gqa_block_cached__dense_activation_relu__decode'

def setup_inputs():

    _w = lambda a: (lambda t: t.to(torch.bfloat16) if t.is_floating_point() else t)(torch.as_tensor(a))

    def _A_setup():
        B, Sq, D = (1, 1, 512)
        Hq, Hkv, Sk, Dh = (32, 8, 32768, 128)
        assert Hq % Hkv == 0, (Hq, Hkv)
        return {'x': _w((lambda *s: torch.randn(*s, dtype=torch.bfloat16) * 0.1)(B, Sq, D)), 'k_cache': _w((lambda *s: torch.randn(*s, dtype=torch.bfloat16) * 0.8)(B, Hkv, Sk, Dh)), 'v_cache': _w((lambda *s: torch.randn(*s, dtype=torch.bfloat16) * 1.6)(B, Hkv, Sk, Dh)), 'wq': _w((lambda *s: torch.randn(*s, dtype=torch.bfloat16) * 0.8)(D, Hq * Dh) * D ** (-0.5)), 'wo': _w((lambda *s: torch.randn(*s, dtype=torch.bfloat16) * 1.6)(Hq * Dh, D) * (Hq * Dh) ** (-0.5))}
    _A_in = _A_setup()

    def _B_setup():
        B, S, D, Dff = (1, 1, 512, 1792)
        return {'x': _w((lambda *s: torch.randn(*s, dtype=torch.bfloat16) * 0.1)(B, S, D)), 'w1': _w((lambda *s: torch.randn(*s, dtype=torch.bfloat16) * 0.1)(D, Dff)), 'w2': _w((lambda *s: torch.randn(*s, dtype=torch.bfloat16) * 0.1)(Dff, D))}
    _B_in = _B_setup()
    return {'A_x': _A_in['x'], 'A_k_cache': _A_in['k_cache'], 'A_v_cache': _A_in['v_cache'], 'A_wq': _A_in['wq'], 'A_wo': _A_in['wo'], 'B_x': _B_in['x'], 'B_w1': _B_in['w1'], 'B_w2': _B_in['w2'], 'c': _w((lambda *s: torch.randn(*s, dtype=torch.bfloat16) * 0.2)(1, 512) * 8.0), 'w_mod': _w((lambda *s: torch.randn(*s, dtype=torch.bfloat16) * 0.2)(512, 6 * 512) * 512 ** (-0.5) * 8.0)}

def reference(A_x, A_k_cache, A_v_cache, A_wq, A_wo, B_x, B_w1, B_w2, c, w_mod):

    def _A_ref(x, k_cache, v_cache, wq, wo):
        B, Sq, D = x.shape
        Hq, Dh = (32, 128)
        Hkv = k_cache.shape[1]
        rep = Hq // Hkv
        q = (lambda x, *d: x.permute(*d))((x @ wq).reshape(B, Sq, Hq, Dh), 0, 2, 1, 3)
        k = (lambda x, n, axis: torch.repeat_interleave(x, n, dim=axis))(k_cache, rep, axis=1)
        v = (lambda x, n, axis: torch.repeat_interleave(x, n, dim=axis))(v_cache, rep, axis=1)
        scores = torch.einsum('bhqd,bhkd->bhqk', q, k) * Dh ** (-0.5)
        p = _softmax(scores, axis=-1)
        o = torch.einsum('bhqk,bhkd->bhqd', p, v)
        return (lambda x, *d: x.permute(*d))(o, 0, 2, 1, 3).reshape(B, Sq, Hq * Dh) @ wo

    def _B_ref(x, w1, w2):
        h = torch.einsum('bsd,df->bsf', x, w1)
        zero = torch.zeros_like(h)
        h = torch.maximum(h, zero)
        return torch.einsum('bsf,fd->bsd', h, w2)
    x = A_x
    mod = (_silu(c) @ w_mod).reshape(c.shape[0], 6, 1, -1)
    sa, ca, ga, sb, cb, gb = (mod[:, 0].clone(), mod[:, 1].clone(), mod[:, 2].clone(), mod[:, 3].clone(), mod[:, 4].clone(), mod[:, 5].clone())
    h = _layernorm(x, axis=-1) * (1 + ca) + sa
    x = x + ga * _A_ref(h, A_k_cache, A_v_cache, A_wq, A_wo)
    h = _layernorm(x, axis=-1) * (1 + cb) + sb
    x = x + gb * _B_ref(h, B_w1, B_w2)
    return x
```

```asm
; @launch grid=(256,1,1) block=(512,1,1) lds=163840
.amdgcn_target "amdgcn-amd-amdhsa--gfx950"
.text
.globl adaLN_cond__gqa_block_cached__dense_activation_relu__decode_kernel
.p2align 8
.type adaLN_cond__gqa_block_cached__dense_activation_relu__decode_kernel,@function
adaLN_cond__gqa_block_cached__dense_activation_relu__decode_kernel:
    s_cmp_ge_u32 s2, 256
    s_cbranch_scc1 L_end
    s_load_dwordx2 s[8:9], s[0:1], 8
    s_cmp_ge_u32 s2, 16
    s_cbranch_scc1 L_nopf
    s_getpc_b64 s[88:89]
L_pc:
    v_lshlrev_b32 v6, 6, v0
    v_min_u32 v6, L_end-L_pc, v6
    v_mov_b32 v9, s89
    v_add_co_u32 v8, vcc, s88, v6
    s_nop 1
    v_addc_co_u32 v9, vcc, 0, v9, vcc
    global_load_dword v24, v[8:9], off
    s_nop 0
L_nopf:
    s_and_b32 s4, s2, 7
    s_lshr_b32 s5, s2, 3
    s_lshr_b32 s40, s4, 1
    s_lshl_b32 s83, s5, 2
    s_add_u32 s40, s40, s83
    s_cmp_lt_u32 s40, 96
    s_cselect_b32 s83, s40, 255
    s_add_u32 s40, s40, 96
    s_bitcmp1_b32 s4, 0
    s_cselect_b32 s40, s83, s40
    s_cmp_lt_u32 s40, 96
    s_cselect_b32 s83, 72, 24
    s_load_dwordx2 s[20:21], s[0:1], s83
    s_load_dwordx16 s[52:67], s[0:1], 0
    s_load_dwordx8 s[68:75], s[0:1], 64
    s_load_dwordx2 s[76:77], s[0:1], 96
    s_cselect_b32 s97, 48, 64
    s_cselect_b32 s96, 0, 48
    v_lshrrev_b32 v4, 6, v0
    v_and_b32 v1, 63, v0
    v_readfirstlane_b32 s3, v4
    v_lshrrev_b32 v28, 3, v1
    v_and_b32 v29, 2, v28
    v_and_b32 v30, 7, v1
    v_xor_b32 v29, v30, v29
    v_lshlrev_b32 v29, 4, v29
    s_lshl_b32 s97, s97, 7
    s_lshl_b32 s22, s97, 9
    s_cmp_lt_u32 s40, 224
    s_cselect_b32 s22, s22, 0
    s_mov_b32 s23, 0x20000
    s_lshr_b32 s83, s40, 1
    s_sub_u32 s96, s83, s96
    s_lshl_b32 s96, s96, 7
    s_and_b32 s101, s40, 1
    s_lshl_b32 s83, s101, 3
    s_add_u32 s83, s83, s3
    s_lshl_b32 s83, s83, 5
    s_mul_i32 s83, s83, s97
    s_add_u32 s96, s96, s83
    v_mul_u32_u24 v30, s97, v28
    v_add_u32 v30, v30, v29
    v_xor_b32 v31, 64, v30
    s_lshl_b32 s97, s97, 3
    s_lshl_b32 s83, s3, 12
    s_add_u32 m0, s83, 32768
    v_and_b32 v4, 12, v1
    v_lshlrev_b32 v2, 6, v4
    v_lshrrev_b32 v4, 4, v1
    v_lshl_add_u32 v2, v4, 6, v2
    v_and_b32 v4, 3, v1
    v_lshl_add_u32 v2, v4, 4, v2
    s_lshl_b32 s81, s4, 23
    s_andn2_b32 s83, s2, 7
    s_add_u32 s83, s83, s3
    s_lshl_b32 s83, s83, 13
    s_add_u32 s81, s81, s83
    s_mov_b32 s10, 0x4000000
    s_mov_b32 s11, 0x20000
    v_mov_b32 v5, 256
    v_mov_b32 v20, 0
    v_mov_b32 v21, 0
    v_mov_b32 v22, 0
    v_mov_b32 v23, 0
    ds_write_b128 v5, v[20:23]
    ds_write_b64 v5, v[20:21] offset:16
    s_setprio 3
    s_waitcnt lgkmcnt(0)
    buffer_load_dwordx4 v30, s[20:23], s96 offen nt lds
    s_add_u32 m0, m0, 1024
    s_add_u32 s96, s96, s97
    buffer_load_dwordx4 v31, s[20:23], s96 offen nt lds
    s_add_u32 m0, m0, 1024
    s_add_u32 s96, s96, s97
    buffer_load_dwordx4 v30, s[20:23], s96 offen nt lds
    s_add_u32 m0, m0, 1024
    s_add_u32 s96, s96, s97
    buffer_load_dwordx4 v31, s[20:23], s96 offen nt lds
    s_barrier
    s_cmp_lt_u32 s40, 224
    s_cselect_b32 s83, s3, 1
    s_cmp_eq_u32 s83, 0
    s_cbranch_scc1 L_aux
    s_add_u32 s46, s81, 0
    buffer_load_dwordx4 v[32:35], v2, s[8:11], s46 offen offset:0 nt
    buffer_load_dwordx4 v[36:39], v2, s[8:11], s46 offen offset:1024 nt
    buffer_load_dwordx4 v[40:43], v2, s[8:11], s46 offen offset:2048 nt
    buffer_load_dwordx4 v[44:47], v2, s[8:11], s46 offen offset:3072 nt
    s_load_dword s93, s[76:77], 0
    v_lshlrev_b32 v3, 4, v1
    s_mov_b64 s[28:29], s[52:53]
    s_mov_b64 s[32:33], s[68:69]
    s_mov_b64 s[16:17], s[76:77]
    s_mov_b64 s[12:13], s[56:57]
    s_mov_b64 s[24:25], s[66:67]
    s_mov_b64 s[36:37], s[72:73]
    s_mov_b64 s[84:85], s[60:61]
    s_mov_b64 s[20:21], s[64:65]
    s_mov_b32 s30, 0x400
    s_mov_b32 s34, 0x400
    s_mov_b32 s14, 0x4000000
    s_mov_b32 s18, 0x10000000
    s_mov_b32 s22, 0x1c0000
    s_mov_b32 s26, 0x1c0000
    s_mov_b32 s38, 0x400
    s_mov_b32 s31, 0x20000
    s_mov_b32 s35, 0x20000
    s_mov_b32 s15, 0x20000
    s_mov_b32 s19, 0x20000
    s_mov_b32 s27, 0x20000
    s_mov_b32 s39, 0x20000
    s_mov_b32 s78, 0x05040100
    s_mov_b32 s79, 0x07060302
    s_mov_b32 s80, 0x3fb8aa3b
    s_mov_b32 s7, 0x40000
    s_getreg_b32 s91, hwreg(HW_REG_XCC_ID)
    s_sub_u32 s83, s5, 24
    s_cmp_lt_u32 s83, 7
    s_cselect_b32 s47, 1, 0
    s_mul_i32 s82, s4, 7
    s_add_u32 s82, s82, s83
    s_lshl_b32 s42, s82, 11
    s_add_u32 s42, s42, 393216
    s_cmp_lt_u32 s5, 16
    s_cselect_b32 s86, 4194304, 0
    s_mov_b32 s87, 0x20000
    s_lshl_b32 s92, s4, 12
    s_lshl_b32 s83, s5, 8
    s_add_u32 s92, s92, s83
    s_add_u32 s92, s92, 1048576
    v_mov_b32 v19, 1
    s_mov_b64 exec, 1
    s_waitcnt vmcnt(4)
    ds_add_u32 v5, v19 offset:4
    s_mov_b64 exec, -1
    s_branch L_stream
L_aux:
    s_load_dword s93, s[76:77], 0
    v_lshlrev_b32 v3, 4, v1
    s_mov_b64 s[28:29], s[52:53]
    s_mov_b64 s[32:33], s[68:69]
    s_mov_b64 s[16:17], s[76:77]
    s_mov_b64 s[12:13], s[56:57]
    s_mov_b64 s[24:25], s[66:67]
    s_mov_b64 s[36:37], s[72:73]
    s_mov_b64 s[84:85], s[60:61]
    s_mov_b64 s[20:21], s[64:65]
    s_mov_b32 s30, 0x400
    s_mov_b32 s34, 0x400
    s_mov_b32 s14, 0x4000000
    s_mov_b32 s18, 0x10000000
    s_mov_b32 s22, 0x1c0000
    s_mov_b32 s26, 0x1c0000
    s_mov_b32 s38, 0x400
    s_mov_b32 s31, 0x20000
    s_mov_b32 s35, 0x20000
    s_mov_b32 s15, 0x20000
    s_mov_b32 s19, 0x20000
    s_mov_b32 s27, 0x20000
    s_mov_b32 s39, 0x20000
    v_and_b32 v4, 31, v1
    v_lshlrev_b32 v4, 4, v4
    v_lshlrev_b32 v6, 2, v1
    s_lshl_b32 s83, s101, 9
    s_cmp_ge_u32 s40, 96
    s_cbranch_scc1 L_ax
    buffer_load_dwordx4 v[8:11], v4, s[32:35], s83 offen
    s_branch L_ay
L_ax:
    buffer_load_dwordx4 v[8:11], v3, s[28:31], 0 offen
    buffer_load_dword v12, v6, s[28:31], s83 offen
    buffer_load_dword v13, v6, s[28:31], s83 offen offset:256
L_ay:
    s_mov_b32 s78, 0x05040100
    s_mov_b32 s79, 0x07060302
    s_mov_b32 s80, 0x3fb8aa3b
    s_mov_b32 s7, 0x40000
    s_getreg_b32 s91, hwreg(HW_REG_XCC_ID)
    s_sub_u32 s83, s5, 24
    s_cmp_lt_u32 s83, 7
    s_cselect_b32 s47, 1, 0
    s_mul_i32 s82, s4, 7
    s_add_u32 s82, s82, s83
    s_lshl_b32 s42, s82, 11
    s_add_u32 s42, s42, 393216
    s_cmp_lt_u32 s5, 16
    s_cselect_b32 s86, 4194304, 0
    s_mov_b32 s87, 0x20000
    s_lshl_b32 s92, s4, 12
    s_lshl_b32 s83, s5, 8
    s_add_u32 s92, s92, s83
    s_add_u32 s92, s92, 1048576
    v_lshrrev_b32 v28, 4, v1
    v_bfe_u32 v29, v1, 2, 2
    v_lshl_add_u32 v30, v28, 3, v29
    v_lshlrev_b32 v30, 7, v30
    v_and_b32 v31, 3, v1
    v_lshl_add_u32 v30, v31, 3, v30
    v_bfe_u32 v29, v1, 3, 2
    v_lshl_add_u32 v16, v29, 5, v30
    v_xor_b32 v17, 32, v16
    v_xor_b32 v18, 64, v16
    v_xor_b32 v19, 96, v16
    v_lshlrev_b32 v7, 4, v28
    s_waitcnt vmcnt(0)
    s_waitcnt lgkmcnt(0)
    s_mul_i32 s6, s93, 0x9E3779B1
    s_add_u32 s6, s6, 0x7F4A7C15
    v_lshlrev_b32 v20, 16, v8
    v_and_b32 v21, 0xffff0000, v8
    v_lshlrev_b32 v22, 16, v9
    v_and_b32 v23, 0xffff0000, v9
    v_lshlrev_b32 v24, 16, v10
    v_and_b32 v25, 0xffff0000, v10
    v_lshlrev_b32 v26, 16, v11
    v_and_b32 v27, 0xffff0000, v11
    s_cmp_ge_u32 s40, 96
    s_nop 0
    s_cbranch_scc1 L_auxq
    s_mov_b32 s83, 0xbfb8aa3b
    v_mul_f32 v224, s83, v20
    v_mul_f32 v225, s83, v21
    v_mul_f32 v226, s83, v22
    v_mul_f32 v227, s83, v23
    v_mul_f32 v228, s83, v24
    v_mul_f32 v229, s83, v25
    v_mul_f32 v230, s83, v26
    v_mul_f32 v231, s83, v27
    v_exp_f32 v224, v224
    v_exp_f32 v225, v225
    v_exp_f32 v226, v226
    v_exp_f32 v227, v227
    v_exp_f32 v228, v228
    v_exp_f32 v229, v229
    v_exp_f32 v230, v230
    v_exp_f32 v231, v231
    v_add_f32 v224, 1.0, v224
    v_add_f32 v225, 1.0, v225
    v_add_f32 v226, 1.0, v226
    v_add_f32 v227, 1.0, v227
    v_add_f32 v228, 1.0, v228
    v_add_f32 v229, 1.0, v229
    v_add_f32 v230, 1.0, v230
    v_add_f32 v231, 1.0, v231
    v_rcp_f32 v224, v224
    v_rcp_f32 v225, v225
    v_rcp_f32 v226, v226
    v_rcp_f32 v227, v227
    v_rcp_f32 v228, v228
    v_rcp_f32 v229, v229
    v_rcp_f32 v230, v230
    v_rcp_f32 v231, v231
    v_mul_f32 v20, v20, v224
    v_mul_f32 v21, v21, v225
    v_mul_f32 v22, v22, v226
    v_mul_f32 v23, v23, v227
    v_mul_f32 v24, v24, v228
    v_mul_f32 v25, v25, v229
    v_mul_f32 v26, v26, v230
    v_mul_f32 v27, v27, v231
    v_cvt_pk_bf16_f32 v8, v20, v21
    v_cvt_pk_bf16_f32 v9, v22, v23
    v_cvt_pk_bf16_f32 v10, v24, v25
    v_cvt_pk_bf16_f32 v11, v26, v27
    ds_write_b128 v4, v[8:11] offset:6144
    s_nop 0
    s_branch L_gemv
L_auxq:
    s_add_u32 s46, s81, 0
    buffer_load_dwordx4 v[32:35], v2, s[8:11], s46 offen offset:0 nt
    buffer_load_dwordx4 v[36:39], v2, s[8:11], s46 offen offset:1024 nt
    buffer_load_dwordx4 v[40:43], v2, s[8:11], s46 offen offset:2048 nt
    buffer_load_dwordx4 v[44:47], v2, s[8:11], s46 offen offset:3072 nt
    s_add_u32 s46, s81, 4096
    buffer_load_dwordx4 v[48:51], v2, s[8:11], s46 offen offset:0 nt
    buffer_load_dwordx4 v[52:55], v2, s[8:11], s46 offen offset:1024 nt
    buffer_load_dwordx4 v[56:59], v2, s[8:11], s46 offen offset:2048 nt
    buffer_load_dwordx4 v[60:63], v2, s[8:11], s46 offen offset:3072 nt
    s_add_u32 s46, s81, 2097152
    buffer_load_dwordx4 v[64:67], v2, s[8:11], s46 offen offset:0 nt
    buffer_load_dwordx4 v[68:71], v2, s[8:11], s46 offen offset:1024 nt
    buffer_load_dwordx4 v[72:75], v2, s[8:11], s46 offen offset:2048 nt
    buffer_load_dwordx4 v[76:79], v2, s[8:11], s46 offen offset:3072 nt
    s_add_u32 s46, s81, 2101248
    buffer_load_dwordx4 v[80:83], v2, s[8:11], s46 offen offset:0 nt
    buffer_load_dwordx4 v[84:87], v2, s[8:11], s46 offen offset:1024 nt
    buffer_load_dwordx4 v[88:91], v2, s[8:11], s46 offen offset:2048 nt
    buffer_load_dwordx4 v[92:95], v2, s[8:11], s46 offen offset:3072 nt
    v_add_f32 v8, v20, v21
    v_add_f32 v8, v8, v22
    v_add_f32 v8, v8, v23
    v_add_f32 v8, v8, v24
    v_add_f32 v8, v8, v25
    v_add_f32 v8, v8, v26
    v_add_f32 v8, v8, v27
    s_nop 1
    v_add_f32_dpp v8, v8, v8 row_ror:1 row_mask:0xf bank_mask:0xf
    s_nop 1
    v_add_f32_dpp v8, v8, v8 row_ror:2 row_mask:0xf bank_mask:0xf
    s_nop 1
    v_add_f32_dpp v8, v8, v8 row_ror:4 row_mask:0xf bank_mask:0xf
    s_nop 1
    v_add_f32_dpp v8, v8, v8 row_ror:8 row_mask:0xf bank_mask:0xf
    v_mov_b32 v10, v8
    s_nop 1
    v_permlane16_swap_b32 v8, v10
    v_add_f32 v8, v8, v10
    v_mov_b32 v10, v8
    s_nop 1
    v_permlane32_swap_b32 v8, v10
    v_add_f32 v8, v8, v10
    v_mul_f32 v8, 0x3b000000, v8
    v_sub_f32 v10, v20, v8
    v_mul_f32 v9, v10, v10
    v_sub_f32 v10, v21, v8
    v_fmac_f32 v9, v10, v10
    v_sub_f32 v10, v22, v8
    v_fmac_f32 v9, v10, v10
    v_sub_f32 v10, v23, v8
    v_fmac_f32 v9, v10, v10
    v_sub_f32 v10, v24, v8
    v_fmac_f32 v9, v10, v10
    v_sub_f32 v10, v25, v8
    v_fmac_f32 v9, v10, v10
    v_sub_f32 v10, v26, v8
    v_fmac_f32 v9, v10, v10
    v_sub_f32 v10, v27, v8
    v_fmac_f32 v9, v10, v10
    s_nop 1
    v_add_f32_dpp v9, v9, v9 row_ror:1 row_mask:0xf bank_mask:0xf
    s_nop 1
    v_add_f32_dpp v9, v9, v9 row_ror:2 row_mask:0xf bank_mask:0xf
    s_nop 1
    v_add_f32_dpp v9, v9, v9 row_ror:4 row_mask:0xf bank_mask:0xf
    s_nop 1
    v_add_f32_dpp v9, v9, v9 row_ror:8 row_mask:0xf bank_mask:0xf
    v_mov_b32 v10, v9
    s_nop 1
    v_permlane16_swap_b32 v9, v10
    v_add_f32 v9, v9, v10
    v_mov_b32 v10, v9
    s_nop 1
    v_permlane32_swap_b32 v9, v10
    v_add_f32 v9, v9, v10
    v_mul_f32 v9, 0x3b000000, v9
    v_cvt_pk_bf16_f32 v10, v8, v9
    v_lshlrev_b32 v8, 16, v10
    v_and_b32 v9, 0xffff0000, v10
    v_add_f32 v9, 0x3727c5ac, v9
    v_cvt_pk_bf16_f32 v9, v9, v9
    v_lshlrev_b32 v9, 16, v9
    v_sqrt_f32 v9, v9
    s_nop 0
    v_cvt_pk_bf16_f32 v9, v9, v9
    v_lshlrev_b32 v9, 16, v9
    v_rcp_f32 v9, v9
    v_lshlrev_b32 v20, 16, v12
    v_and_b32 v21, 0xffff0000, v12
    v_sub_f32 v20, v20, v8
    v_sub_f32 v21, v21, v8
    v_cvt_pk_bf16_f32 v10, v20, v21
    v_lshlrev_b32 v20, 16, v10
    v_and_b32 v21, 0xffff0000, v10
    v_mul_f32 v20, v20, v9
    v_mul_f32 v21, v21, v9
    v_cvt_pk_bf16_f32 v10, v20, v21
    v_lshlrev_b32 v20, 16, v10
    v_and_b32 v21, 0xffff0000, v10
    v_lshlrev_b32 v22, 16, v13
    v_and_b32 v23, 0xffff0000, v13
    v_sub_f32 v22, v22, v8
    v_sub_f32 v23, v23, v8
    v_cvt_pk_bf16_f32 v10, v22, v23
    v_lshlrev_b32 v22, 16, v10
    v_and_b32 v23, 0xffff0000, v10
    v_mul_f32 v22, v22, v9
    v_mul_f32 v23, v23, v9
    v_cvt_pk_bf16_f32 v10, v22, v23
    v_lshlrev_b32 v22, 16, v10
    v_and_b32 v23, 0xffff0000, v10
    v_lshrrev_b32 v28, 5, v1
    v_lshl_add_u32 v4, v28, 10, v4
    s_lshl_b32 s97, s101, 12
    s_add_u32 s97, s97, 786432
    s_add_u32 s96, s97, 8192
L_pollmod:
    buffer_load_dwordx4 v[224:227], v4, s[16:19], s97 offen offset:0 sc1
    buffer_load_dwordx4 v[228:231], v4, s[16:19], s97 offen offset:512 sc1
    buffer_load_dwordx4 v[232:235], v4, s[16:19], s97 offen offset:2048 sc1
    buffer_load_dwordx4 v[236:239], v4, s[16:19], s97 offen offset:2560 sc1
    buffer_load_dwordx4 v[240:243], v4, s[16:19], s96 offen offset:0 sc1
    buffer_load_dwordx4 v[244:247], v4, s[16:19], s96 offen offset:512 sc1
    buffer_load_dwordx4 v[248:251], v4, s[16:19], s96 offen offset:2048 sc1
    buffer_load_dwordx4 v[252:255], v4, s[16:19], s96 offen offset:2560 sc1
    s_waitcnt vmcnt(0)
    v_max3_u32 v28, v225, v227, v229
    v_min3_u32 v29, v225, v227, v229
    v_max3_u32 v28, v28, v231, v233
    v_min3_u32 v29, v29, v231, v233
    v_max3_u32 v28, v28, v235, v237
    v_min3_u32 v29, v29, v235, v237
    v_max3_u32 v28, v28, v239, v241
    v_min3_u32 v29, v29, v239, v241
    v_max3_u32 v28, v28, v243, v245
    v_min3_u32 v29, v29, v243, v245
    v_max3_u32 v28, v28, v247, v249
    v_min3_u32 v29, v29, v247, v249
    v_max3_u32 v28, v28, v251, v253
    v_min3_u32 v29, v29, v251, v253
    v_max3_u32 v28, v28, v255, s6
    v_min3_u32 v29, v29, v255, s6
    v_cmp_ne_u32 vcc, v28, v29
    s_nop 0
    s_cbranch_vccz L_gotmod
    s_sleep 2
    s_sub_u32 s7, s7, 1
    s_cbranch_scc0 L_pollmod
    s_branch L_end
L_gotmod:
    v_add_f32 v224, v224, v228
    v_add_f32 v226, v226, v230
    v_add_f32 v240, v240, v244
    v_add_f32 v242, v242, v246
    v_cvt_pk_bf16_f32 v10, v224, v226
    v_lshlrev_b32 v224, 16, v10
    v_and_b32 v226, 0xffff0000, v10
    v_cvt_pk_bf16_f32 v10, v240, v242
    v_lshlrev_b32 v240, 16, v10
    v_and_b32 v242, 0xffff0000, v10
    v_add_f32 v240, 1.0, v240
    v_add_f32 v242, 1.0, v242
    v_cvt_pk_bf16_f32 v10, v240, v242
    v_lshlrev_b32 v240, 16, v10
    v_and_b32 v242, 0xffff0000, v10
    v_mul_f32 v20, v20, v240
    v_mul_f32 v21, v21, v242
    v_cvt_pk_bf16_f32 v10, v20, v21
    v_lshlrev_b32 v20, 16, v10
    v_and_b32 v21, 0xffff0000, v10
    v_add_f32 v20, v20, v224
    v_add_f32 v21, v21, v226
    v_cvt_pk_bf16_f32 v20, v20, v21
    ds_write_b32 v6, v20 offset:6144
    v_add_f32 v232, v232, v236
    v_add_f32 v234, v234, v238
    v_add_f32 v248, v248, v252
    v_add_f32 v250, v250, v254
    v_cvt_pk_bf16_f32 v10, v232, v234
    v_lshlrev_b32 v232, 16, v10
    v_and_b32 v234, 0xffff0000, v10
    v_cvt_pk_bf16_f32 v10, v248, v250
    v_lshlrev_b32 v248, 16, v10
    v_and_b32 v250, 0xffff0000, v10
    v_add_f32 v248, 1.0, v248
    v_add_f32 v250, 1.0, v250
    v_cvt_pk_bf16_f32 v10, v248, v250
    v_lshlrev_b32 v248, 16, v10
    v_and_b32 v250, 0xffff0000, v10
    v_mul_f32 v22, v22, v248
    v_mul_f32 v23, v23, v250
    v_cvt_pk_bf16_f32 v10, v22, v23
    v_lshlrev_b32 v22, 16, v10
    v_and_b32 v23, 0xffff0000, v10
    v_add_f32 v22, v22, v232
    v_add_f32 v23, v23, v234
    v_cvt_pk_bf16_f32 v22, v22, v23
    ds_write_b32 v6, v22 offset:6400
    s_nop 0
L_gemv:
    ds_read_b32 v28, v5 offset:4
    s_waitcnt lgkmcnt(0)
    v_readfirstlane_b32 s100, v28
    s_cmp_lg_u32 s100, 7
    s_nop 3
    s_cbranch_scc1 L_gemv
    ds_read_b128 v[160:163], v7 offset:6144
    ds_read_b64_tr_b16 v[164:165], v16 offset:32768
    ds_read_b64_tr_b16 v[166:167], v16 offset:33280
    ds_read_b64_tr_b16 v[168:169], v17 offset:32768
    ds_read_b64_tr_b16 v[170:171], v17 offset:33280
    ds_read_b64_tr_b16 v[172:173], v18 offset:32768
    ds_read_b64_tr_b16 v[174:175], v18 offset:33280
    ds_read_b64_tr_b16 v[176:177], v19 offset:32768
    ds_read_b64_tr_b16 v[178:179], v19 offset:33280
    ds_read_b128 v[180:183], v7 offset:6208
    ds_read_b64_tr_b16 v[184:185], v16 offset:36864
    ds_read_b64_tr_b16 v[186:187], v16 offset:37376
    ds_read_b64_tr_b16 v[188:189], v17 offset:36864
    ds_read_b64_tr_b16 v[190:191], v17 offset:37376
    ds_read_b64_tr_b16 v[192:193], v18 offset:36864
    ds_read_b64_tr_b16 v[194:195], v18 offset:37376
    ds_read_b64_tr_b16 v[196:197], v19 offset:36864
    ds_read_b64_tr_b16 v[198:199], v19 offset:37376
    s_lshl_b32 s97, s40, 9
    s_add_u32 s97, s97, 786432
    v_lshlrev_b32 v4, 3, v1
    s_waitcnt lgkmcnt(9)
    ds_read_b128 v[200:203], v7 offset:6272
    ds_read_b64_tr_b16 v[204:205], v16 offset:40960
    ds_read_b64_tr_b16 v[206:207], v16 offset:41472
    ds_read_b64_tr_b16 v[208:209], v17 offset:40960
    ds_read_b64_tr_b16 v[210:211], v17 offset:41472
    ds_read_b64_tr_b16 v[212:213], v18 offset:40960
    ds_read_b64_tr_b16 v[214:215], v18 offset:41472
    ds_read_b64_tr_b16 v[216:217], v19 offset:40960
    ds_read_b64_tr_b16 v[218:219], v19 offset:41472
    v_mfma_f32_16x16x32_bf16 v[240:243], v[160:163], v[164:167], 0
    v_mfma_f32_16x16x32_bf16 v[244:247], v[160:163], v[168:171], 0
    v_mfma_f32_16x16x32_bf16 v[248:251], v[160:163], v[172:175], 0
    v_mfma_f32_16x16x32_bf16 v[252:255], v[160:163], v[176:179], 0
    s_waitcnt lgkmcnt(9)
    ds_read_b128 v[160:163], v7 offset:6336
    ds_read_b64_tr_b16 v[164:165], v16 offset:45056
    ds_read_b64_tr_b16 v[166:167], v16 offset:45568
    ds_read_b64_tr_b16 v[168:169], v17 offset:45056
    ds_read_b64_tr_b16 v[170:171], v17 offset:45568
    ds_read_b64_tr_b16 v[172:173], v18 offset:45056
    ds_read_b64_tr_b16 v[174:175], v18 offset:45568
    ds_read_b64_tr_b16 v[176:177], v19 offset:45056
    ds_read_b64_tr_b16 v[178:179], v19 offset:45568
    v_mfma_f32_16x16x32_bf16 v[240:243], v[180:183], v[184:187], v[240:243]
    v_mfma_f32_16x16x32_bf16 v[244:247], v[180:183], v[188:191], v[244:247]
    v_mfma_f32_16x16x32_bf16 v[248:251], v[180:183], v[192:195], v[248:251]
    v_mfma_f32_16x16x32_bf16 v[252:255], v[180:183], v[196:199], v[252:255]
    s_waitcnt lgkmcnt(9)
    ds_read_b128 v[180:183], v7 offset:6400
    ds_read_b64_tr_b16 v[184:185], v16 offset:49152
    ds_read_b64_tr_b16 v[186:187], v16 offset:49664
    ds_read_b64_tr_b16 v[188:189], v17 offset:49152
    ds_read_b64_tr_b16 v[190:191], v17 offset:49664
    ds_read_b64_tr_b16 v[192:193], v18 offset:49152
    ds_read_b64_tr_b16 v[194:195], v18 offset:49664
    ds_read_b64_tr_b16 v[196:197], v19 offset:49152
    ds_read_b64_tr_b16 v[198:199], v19 offset:49664
    v_mfma_f32_16x16x32_bf16 v[240:243], v[200:203], v[204:207], v[240:243]
    v_mfma_f32_16x16x32_bf16 v[244:247], v[200:203], v[208:211], v[244:247]
    v_mfma_f32_16x16x32_bf16 v[248:251], v[200:203], v[212:215], v[248:251]
    v_mfma_f32_16x16x32_bf16 v[252:255], v[200:203], v[216:219], v[252:255]
    s_waitcnt lgkmcnt(9)
    ds_read_b128 v[200:203], v7 offset:6464
    ds_read_b64_tr_b16 v[204:205], v16 offset:53248
    ds_read_b64_tr_b16 v[206:207], v16 offset:53760
    ds_read_b64_tr_b16 v[208:209], v17 offset:53248
    ds_read_b64_tr_b16 v[210:211], v17 offset:53760
    ds_read_b64_tr_b16 v[212:213], v18 offset:53248
    ds_read_b64_tr_b16 v[214:215], v18 offset:53760
    ds_read_b64_tr_b16 v[216:217], v19 offset:53248
    ds_read_b64_tr_b16 v[218:219], v19 offset:53760
    v_mfma_f32_16x16x32_bf16 v[240:243], v[160:163], v[164:167], v[240:243]
    v_mfma_f32_16x16x32_bf16 v[244:247], v[160:163], v[168:171], v[244:247]
    v_mfma_f32_16x16x32_bf16 v[248:251], v[160:163], v[172:175], v[248:251]
    v_mfma_f32_16x16x32_bf16 v[252:255], v[160:163], v[176:179], v[252:255]
    s_waitcnt lgkmcnt(9)
    ds_read_b128 v[160:163], v7 offset:6528
    ds_read_b64_tr_b16 v[164:165], v16 offset:57344
    ds_read_b64_tr_b16 v[166:167], v16 offset:57856
    ds_read_b64_tr_b16 v[168:169], v17 offset:57344
    ds_read_b64_tr_b16 v[170:171], v17 offset:57856
    ds_read_b64_tr_b16 v[172:173], v18 offset:57344
    ds_read_b64_tr_b16 v[174:175], v18 offset:57856
    ds_read_b64_tr_b16 v[176:177], v19 offset:57344
    ds_read_b64_tr_b16 v[178:179], v19 offset:57856
    v_mfma_f32_16x16x32_bf16 v[240:243], v[180:183], v[184:187], v[240:243]
    v_mfma_f32_16x16x32_bf16 v[244:247], v[180:183], v[188:191], v[244:247]
    v_mfma_f32_16x16x32_bf16 v[248:251], v[180:183], v[192:195], v[248:251]
    v_mfma_f32_16x16x32_bf16 v[252:255], v[180:183], v[196:199], v[252:255]
    s_waitcnt lgkmcnt(9)
    ds_read_b128 v[180:183], v7 offset:6592
    ds_read_b64_tr_b16 v[184:185], v16 offset:61440
    ds_read_b64_tr_b16 v[186:187], v16 offset:61952
    ds_read_b64_tr_b16 v[188:189], v17 offset:61440
    ds_read_b64_tr_b16 v[190:191], v17 offset:61952
    ds_read_b64_tr_b16 v[192:193], v18 offset:61440
    ds_read_b64_tr_b16 v[194:195], v18 offset:61952
    ds_read_b64_tr_b16 v[196:197], v19 offset:61440
    ds_read_b64_tr_b16 v[198:199], v19 offset:61952
    v_mfma_f32_16x16x32_bf16 v[240:243], v[200:203], v[204:207], v[240:243]
    v_mfma_f32_16x16x32_bf16 v[244:247], v[200:203], v[208:211], v[244:247]
    v_mfma_f32_16x16x32_bf16 v[248:251], v[200:203], v[212:215], v[248:251]
    v_mfma_f32_16x16x32_bf16 v[252:255], v[200:203], v[216:219], v[252:255]
    s_waitcnt lgkmcnt(9)
    v_mfma_f32_16x16x32_bf16 v[240:243], v[160:163], v[164:167], v[240:243]
    v_mfma_f32_16x16x32_bf16 v[244:247], v[160:163], v[168:171], v[244:247]
    v_mfma_f32_16x16x32_bf16 v[248:251], v[160:163], v[172:175], v[248:251]
    v_mfma_f32_16x16x32_bf16 v[252:255], v[160:163], v[176:179], v[252:255]
    s_waitcnt lgkmcnt(0)
    v_mfma_f32_16x16x32_bf16 v[240:243], v[180:183], v[184:187], v[240:243]
    v_mfma_f32_16x16x32_bf16 v[244:247], v[180:183], v[188:191], v[244:247]
    v_mfma_f32_16x16x32_bf16 v[248:251], v[180:183], v[192:195], v[248:251]
    v_mfma_f32_16x16x32_bf16 v[252:255], v[180:183], v[196:199], v[252:255]
    v_mov_b32 v9, s6
    s_nop 4
    v_mov_b32_dpp v240, v244 quad_perm:[0,1,2,3] row_mask:0x2 bank_mask:0xf
    v_mov_b32_dpp v240, v248 quad_perm:[0,1,2,3] row_mask:0x4 bank_mask:0xf
    v_mov_b32_dpp v240, v252 quad_perm:[0,1,2,3] row_mask:0x8 bank_mask:0xf
    v_mov_b32 v8, v240
    s_cmp_lt_u32 s40, 32
    s_cselect_b32 s101, 1, s101
    s_cmp_eq_u32 s101, 0
    s_cbranch_scc1 L_owner
    buffer_store_dwordx2 v[8:9], v4, s[16:19], s97 offen sc1
    s_cmp_ge_u32 s40, 96
    s_cbranch_scc1 L_cu2
    s_branch L_cu0
L_owner:
    s_cmp_ge_u32 s40, 96
    s_cbranch_scc1 L_own2
    s_add_u32 s46, s81, 0
    buffer_load_dwordx4 v[32:35], v2, s[8:11], s46 offen offset:0 nt
    buffer_load_dwordx4 v[36:39], v2, s[8:11], s46 offen offset:1024 nt
    buffer_load_dwordx4 v[40:43], v2, s[8:11], s46 offen offset:2048 nt
    buffer_load_dwordx4 v[44:47], v2, s[8:11], s46 offen offset:3072 nt
    s_add_u32 s46, s81, 4096
    buffer_load_dwordx4 v[48:51], v2, s[8:11], s46 offen offset:0 nt
    buffer_load_dwordx4 v[52:55], v2, s[8:11], s46 offen offset:1024 nt
    buffer_load_dwordx4 v[56:59], v2, s[8:11], s46 offen offset:2048 nt
    buffer_load_dwordx4 v[60:63], v2, s[8:11], s46 offen offset:3072 nt
    s_add_u32 s46, s81, 2097152
    buffer_load_dwordx4 v[64:67], v2, s[8:11], s46 offen offset:0 nt
    buffer_load_dwordx4 v[68:71], v2, s[8:11], s46 offen offset:1024 nt
    buffer_load_dwordx4 v[72:75], v2, s[8:11], s46 offen offset:2048 nt
    buffer_load_dwordx4 v[76:79], v2, s[8:11], s46 offen offset:3072 nt
    s_add_u32 s46, s81, 2101248
    buffer_load_dwordx4 v[80:83], v2, s[8:11], s46 offen offset:0 nt
    buffer_load_dwordx4 v[84:87], v2, s[8:11], s46 offen offset:1024 nt
    buffer_load_dwordx4 v[88:91], v2, s[8:11], s46 offen offset:2048 nt
    buffer_load_dwordx4 v[92:95], v2, s[8:11], s46 offen offset:3072 nt
L_own2:
    s_add_u32 s46, s81, 4194304
    buffer_load_dwordx4 v[96:99], v2, s[8:11], s46 offen offset:0 nt
    buffer_load_dwordx4 v[100:103], v2, s[8:11], s46 offen offset:1024 nt
    buffer_load_dwordx4 v[104:107], v2, s[8:11], s46 offen offset:2048 nt
    buffer_load_dwordx4 v[108:111], v2, s[8:11], s46 offen offset:3072 nt
    s_add_u32 s46, s81, 4198400
    buffer_load_dwordx4 v[112:115], v2, s[8:11], s46 offen offset:0 nt
    buffer_load_dwordx4 v[116:119], v2, s[8:11], s46 offen offset:1024 nt
    buffer_load_dwordx4 v[120:123], v2, s[8:11], s46 offen offset:2048 nt
    buffer_load_dwordx4 v[124:127], v2, s[8:11], s46 offen offset:3072 nt
L_pollred:
    buffer_load_dwordx2 v[10:11], v4, s[16:19], s97 offen offset:512 sc1
    s_waitcnt vmcnt(0)
    v_cmp_ne_u32 vcc, s6, v11
    s_nop 0
    s_cbranch_vccz L_gotred
    s_sub_u32 s7, s7, 1
    s_cbranch_scc0 L_pollred
    s_branch L_end
L_gotred:
    v_add_f32 v8, v8, v10
    s_lshl_b32 s83, s40, 7
    s_add_u32 s83, s83, 4096
    v_mov_b32_dpp v10, v8 quad_perm:[1,1,3,3] row_mask:0xf bank_mask:0xf
    v_cvt_pk_bf16_f32 v8, v8, v10
    s_mov_b32 exec_lo, 0x55555555
    s_mov_b32 exec_hi, 0x55555555
    buffer_store_dwordx2 v[8:9], v6, s[16:19], s83 offen sc1
    s_mov_b64 exec, -1
    s_branch L_cu3
L_cu0:
    s_add_u32 s46, s81, 0
    s_waitcnt vmcnt(8)
    buffer_load_dwordx4 v[32:35], v2, s[8:11], s46 offen offset:0 nt
    s_waitcnt vmcnt(8)
    buffer_load_dwordx4 v[36:39], v2, s[8:11], s46 offen offset:1024 nt
    s_waitcnt vmcnt(8)
    buffer_load_dwordx4 v[40:43], v2, s[8:11], s46 offen offset:2048 nt
    s_waitcnt vmcnt(8)
    buffer_load_dwordx4 v[44:47], v2, s[8:11], s46 offen offset:3072 nt
    s_add_u32 s46, s81, 4096
    s_waitcnt vmcnt(8)
    buffer_load_dwordx4 v[48:51], v2, s[8:11], s46 offen offset:0 nt
    s_waitcnt vmcnt(8)
    buffer_load_dwordx4 v[52:55], v2, s[8:11], s46 offen offset:1024 nt
    s_waitcnt vmcnt(8)
    buffer_load_dwordx4 v[56:59], v2, s[8:11], s46 offen offset:2048 nt
    s_waitcnt vmcnt(8)
    buffer_load_dwordx4 v[60:63], v2, s[8:11], s46 offen offset:3072 nt
L_cu1:
    s_add_u32 s46, s81, 2097152
    s_waitcnt vmcnt(8)
    buffer_load_dwordx4 v[64:67], v2, s[8:11], s46 offen offset:0 nt
    s_waitcnt vmcnt(8)
    buffer_load_dwordx4 v[68:71], v2, s[8:11], s46 offen offset:1024 nt
    s_waitcnt vmcnt(8)
    buffer_load_dwordx4 v[72:75], v2, s[8:11], s46 offen offset:2048 nt
    s_waitcnt vmcnt(8)
    buffer_load_dwordx4 v[76:79], v2, s[8:11], s46 offen offset:3072 nt
    s_add_u32 s46, s81, 2101248
    s_waitcnt vmcnt(8)
    buffer_load_dwordx4 v[80:83], v2, s[8:11], s46 offen offset:0 nt
    s_waitcnt vmcnt(8)
    buffer_load_dwordx4 v[84:87], v2, s[8:11], s46 offen offset:1024 nt
    s_waitcnt vmcnt(8)
    buffer_load_dwordx4 v[88:91], v2, s[8:11], s46 offen offset:2048 nt
    s_waitcnt vmcnt(8)
    buffer_load_dwordx4 v[92:95], v2, s[8:11], s46 offen offset:3072 nt
L_cu2:
    s_add_u32 s46, s81, 4194304
    s_waitcnt vmcnt(8)
    buffer_load_dwordx4 v[96:99], v2, s[8:11], s46 offen offset:0 nt
    s_waitcnt vmcnt(8)
    buffer_load_dwordx4 v[100:103], v2, s[8:11], s46 offen offset:1024 nt
    s_waitcnt vmcnt(8)
    buffer_load_dwordx4 v[104:107], v2, s[8:11], s46 offen offset:2048 nt
    s_waitcnt vmcnt(8)
    buffer_load_dwordx4 v[108:111], v2, s[8:11], s46 offen offset:3072 nt
    s_add_u32 s46, s81, 4198400
    s_waitcnt vmcnt(8)
    buffer_load_dwordx4 v[112:115], v2, s[8:11], s46 offen offset:0 nt
    s_waitcnt vmcnt(8)
    buffer_load_dwordx4 v[116:119], v2, s[8:11], s46 offen offset:1024 nt
    s_waitcnt vmcnt(8)
    buffer_load_dwordx4 v[120:123], v2, s[8:11], s46 offen offset:2048 nt
    s_waitcnt vmcnt(8)
    buffer_load_dwordx4 v[124:127], v2, s[8:11], s46 offen offset:3072 nt
L_cu3:
    s_cmp_lt_u32 s40, 96
    s_cbranch_scc1 L_sk3
    s_add_u32 s46, s81, 6291456
    s_waitcnt vmcnt(8)
    buffer_load_dwordx4 v[128:131], v2, s[8:11], s46 offen offset:0 nt
    s_waitcnt vmcnt(8)
    buffer_load_dwordx4 v[132:135], v2, s[8:11], s46 offen offset:1024 nt
    s_waitcnt vmcnt(8)
    buffer_load_dwordx4 v[136:139], v2, s[8:11], s46 offen offset:2048 nt
    s_waitcnt vmcnt(8)
    buffer_load_dwordx4 v[140:143], v2, s[8:11], s46 offen offset:3072 nt
    s_add_u32 s46, s81, 6295552
    s_waitcnt vmcnt(8)
    buffer_load_dwordx4 v[144:147], v2, s[8:11], s46 offen offset:0 nt
    s_waitcnt vmcnt(8)
    buffer_load_dwordx4 v[148:151], v2, s[8:11], s46 offen offset:1024 nt
    s_waitcnt vmcnt(8)
    buffer_load_dwordx4 v[152:155], v2, s[8:11], s46 offen offset:2048 nt
    s_waitcnt vmcnt(8)
    buffer_load_dwordx4 v[156:159], v2, s[8:11], s46 offen offset:3072 nt
L_cu4:
    s_add_u32 s46, s81, 0
    s_waitcnt vmcnt(8)
    buffer_load_dwordx4 v[160:163], v3, s[12:15], s46 offen offset:0 nt
    s_waitcnt vmcnt(8)
    buffer_load_dwordx4 v[164:167], v3, s[12:15], s46 offen offset:1024 nt
    s_waitcnt vmcnt(8)
    buffer_load_dwordx4 v[168:171], v3, s[12:15], s46 offen offset:2048 nt
    s_waitcnt vmcnt(8)
    buffer_load_dwordx4 v[172:175], v3, s[12:15], s46 offen offset:3072 nt
    s_add_u32 s46, s81, 4096
    s_waitcnt vmcnt(8)
    buffer_load_dwordx4 v[176:179], v3, s[12:15], s46 offen offset:0 nt
    s_waitcnt vmcnt(8)
    buffer_load_dwordx4 v[180:183], v3, s[12:15], s46 offen offset:1024 nt
    s_waitcnt vmcnt(8)
    buffer_load_dwordx4 v[184:187], v3, s[12:15], s46 offen offset:2048 nt
    s_waitcnt vmcnt(8)
    buffer_load_dwordx4 v[188:191], v3, s[12:15], s46 offen offset:3072 nt
    s_branch L_v1
L_stream:
    s_add_u32 s46, s81, 4096
    buffer_load_dwordx4 v[48:51], v2, s[8:11], s46 offen offset:0 nt
    buffer_load_dwordx4 v[52:55], v2, s[8:11], s46 offen offset:1024 nt
    s_waitcnt vmcnt(5)
    buffer_load_dwordx4 v[56:59], v2, s[8:11], s46 offen offset:2048 nt
    s_waitcnt vmcnt(5)
    buffer_load_dwordx4 v[60:63], v2, s[8:11], s46 offen offset:3072 nt
    s_cmp_lg_u32 s3, 1
    s_cbranch_scc1 L_sk1
    v_mov_b32 v20, -1
    v_mov_b32 v21, -1
    v_mov_b32 v22, -1
    v_mov_b32 v23, -1
    s_cmp_ge_u32 s5, 16
    s_nop 0
    s_cbranch_scc1 L_noclr2
    s_mov_b64 exec, 0xffff
    buffer_store_dwordx4 v[20:23], v3, s[16:19], s92 offen sc1
    s_mov_b64 exec, -1
    s_nop 0
L_noclr2:
    s_cmp_eq_u32 s47, 0
    s_cbranch_scc1 L_noclr0
    s_mov_b32 s83, s42
    buffer_store_dwordx4 v[20:23], v3, s[16:19], s83 offen offset:0 sc1
    buffer_store_dwordx4 v[20:23], v3, s[16:19], s83 offen offset:1024 sc1
    s_nop 1
L_noclr0:
    s_add_u32 s46, s81, 2097152
    s_waitcnt vmcnt(5)
    buffer_load_dwordx4 v[64:67], v2, s[8:11], s46 offen offset:0 nt
    s_waitcnt vmcnt(5)
    buffer_load_dwordx4 v[68:71], v2, s[8:11], s46 offen offset:1024 nt
    s_waitcnt vmcnt(5)
    buffer_load_dwordx4 v[72:75], v2, s[8:11], s46 offen offset:2048 nt
    s_waitcnt vmcnt(5)
    buffer_load_dwordx4 v[76:79], v2, s[8:11], s46 offen offset:3072 nt
    s_waitcnt lgkmcnt(0)
    s_mul_i32 s6, s93, 0x9E3779B1
    s_add_u32 s6, s6, 0x7F4A7C15
    s_lshl_b32 s83, s5, 7
    s_lshl_b32 s100, s4, 12
    s_add_u32 s83, s83, s100
    s_add_u32 s83, s83, 65536
    v_mov_b32 v28, s91
    v_mov_b32 v29, s6
    v_mov_b32 v30, s91
    v_mov_b32 v31, s6
    s_mov_b64 exec, 0xff
    s_waitcnt vmcnt(4)
    buffer_store_dwordx4 v[28:31], v3, s[16:19], s83 offen sc1
    s_mov_b64 exec, -1
    s_nop 0
    s_branch L_k1b
L_sk1:
    s_add_u32 s46, s81, 2097152
    s_waitcnt vmcnt(5)
    buffer_load_dwordx4 v[64:67], v2, s[8:11], s46 offen offset:0 nt
    s_waitcnt vmcnt(5)
    buffer_load_dwordx4 v[68:71], v2, s[8:11], s46 offen offset:1024 nt
    s_waitcnt vmcnt(5)
    buffer_load_dwordx4 v[72:75], v2, s[8:11], s46 offen offset:2048 nt
    s_waitcnt vmcnt(5)
    buffer_load_dwordx4 v[76:79], v2, s[8:11], s46 offen offset:3072 nt
    s_waitcnt lgkmcnt(0)
    s_mul_i32 s6, s93, 0x9E3779B1
    s_add_u32 s6, s6, 0x7F4A7C15
L_k1b:
L_j12:
    s_add_u32 s46, s81, 2101248
    s_waitcnt vmcnt(5)
    buffer_load_dwordx4 v[80:83], v2, s[8:11], s46 offen offset:0 nt
    s_waitcnt vmcnt(5)
    buffer_load_dwordx4 v[84:87], v2, s[8:11], s46 offen offset:1024 nt
    s_waitcnt vmcnt(5)
    buffer_load_dwordx4 v[88:91], v2, s[8:11], s46 offen offset:2048 nt
    s_waitcnt vmcnt(5)
    buffer_load_dwordx4 v[92:95], v2, s[8:11], s46 offen offset:3072 nt
L_sk2:
L_j16:
    s_add_u32 s46, s81, 4194304
    s_waitcnt vmcnt(5)
    buffer_load_dwordx4 v[96:99], v2, s[8:11], s46 offen offset:0 nt
    s_waitcnt vmcnt(5)
    buffer_load_dwordx4 v[100:103], v2, s[8:11], s46 offen offset:1024 nt
    s_waitcnt vmcnt(5)
    buffer_load_dwordx4 v[104:107], v2, s[8:11], s46 offen offset:2048 nt
    s_waitcnt vmcnt(5)
    buffer_load_dwordx4 v[108:111], v2, s[8:11], s46 offen offset:3072 nt
L_j20:
    s_add_u32 s46, s81, 4198400
    s_waitcnt vmcnt(5)
    buffer_load_dwordx4 v[112:115], v2, s[8:11], s46 offen offset:0 nt
    s_waitcnt vmcnt(5)
    buffer_load_dwordx4 v[116:119], v2, s[8:11], s46 offen offset:1024 nt
    s_waitcnt vmcnt(5)
    buffer_load_dwordx4 v[120:123], v2, s[8:11], s46 offen offset:2048 nt
    s_waitcnt vmcnt(5)
    buffer_load_dwordx4 v[124:127], v2, s[8:11], s46 offen offset:3072 nt
L_sk3:
L_j24:
    s_setprio 2
    s_add_u32 s46, s81, 6291456
    s_waitcnt vmcnt(5)
    buffer_load_dwordx4 v[128:131], v2, s[8:11], s46 offen offset:0 nt
    s_waitcnt vmcnt(5)
    buffer_load_dwordx4 v[132:135], v2, s[8:11], s46 offen offset:1024 nt
    s_waitcnt vmcnt(5)
    buffer_load_dwordx4 v[136:139], v2, s[8:11], s46 offen offset:2048 nt
    s_waitcnt vmcnt(5)
    buffer_load_dwordx4 v[140:143], v2, s[8:11], s46 offen offset:3072 nt
L_j28:
    s_add_u32 s46, s81, 6295552
    s_waitcnt vmcnt(5)
    buffer_load_dwordx4 v[144:147], v2, s[8:11], s46 offen offset:0 nt
    s_waitcnt vmcnt(5)
    buffer_load_dwordx4 v[148:151], v2, s[8:11], s46 offen offset:1024 nt
    s_waitcnt vmcnt(5)
    buffer_load_dwordx4 v[152:155], v2, s[8:11], s46 offen offset:2048 nt
    s_waitcnt vmcnt(5)
    buffer_load_dwordx4 v[156:159], v2, s[8:11], s46 offen offset:3072 nt
L_sk4:
L_j32:
    s_add_u32 s46, s81, 0
    s_waitcnt vmcnt(5)
    buffer_load_dwordx4 v[160:163], v3, s[12:15], s46 offen offset:0 nt
    s_add_u32 s46, s81, 0
    s_waitcnt vmcnt(5)
    buffer_load_dwordx4 v[164:167], v3, s[12:15], s46 offen offset:1024 nt
    s_add_u32 s46, s81, 0
    s_waitcnt vmcnt(5)
    buffer_load_dwordx4 v[168:171], v3, s[12:15], s46 offen offset:2048 nt
    s_add_u32 s46, s81, 0
    s_waitcnt vmcnt(5)
    buffer_load_dwordx4 v[172:175], v3, s[12:15], s46 offen offset:3072 nt
L_j36:
    s_add_u32 s46, s81, 4096
    s_waitcnt vmcnt(5)
    buffer_load_dwordx4 v[176:179], v3, s[12:15], s46 offen offset:0 nt
    s_add_u32 s46, s81, 4096
    s_waitcnt vmcnt(5)
    buffer_load_dwordx4 v[180:183], v3, s[12:15], s46 offen offset:1024 nt
    s_add_u32 s46, s81, 4096
    s_waitcnt vmcnt(5)
    buffer_load_dwordx4 v[184:187], v3, s[12:15], s46 offen offset:2048 nt
    s_add_u32 s46, s81, 4096
    s_waitcnt vmcnt(5)
    buffer_load_dwordx4 v[188:191], v3, s[12:15], s46 offen offset:3072 nt
L_v1:
    s_add_u32 s46, s81, 2097152
    s_waitcnt vmcnt(5)
    buffer_load_dwordx4 v[192:195], v3, s[12:15], s46 offen offset:0 nt
    s_add_u32 s46, s81, 2097152
    s_waitcnt vmcnt(5)
    buffer_load_dwordx4 v[196:199], v3, s[12:15], s46 offen offset:1024 nt
    s_add_u32 s46, s81, 2097152
    s_waitcnt vmcnt(5)
    buffer_load_dwordx4 v[200:203], v3, s[12:15], s46 offen offset:2048 nt
    v_mov_b32 v4, 1
    s_mov_b64 exec, 1
    ds_add_rtn_u32 v4, v5, v4 offset:12
    s_mov_b64 exec, -1
    s_add_u32 s46, s81, 2097152
    s_waitcnt vmcnt(5)
    buffer_load_dwordx4 v[204:207], v3, s[12:15], s46 offen offset:3072 nt
    s_cmp_eq_u32 s47, 0
    s_cbranch_scc1 L_nomdma
    s_lshl_b32 s83, s3, 10
    s_add_u32 m0, s83, 24576
    s_add_u32 s83, s83, 8192
    buffer_load_dwordx4 v3, s[16:19], s83 offen sc1 lds
L_nomdma:
    v_lshlrev_b32 v18, 1, v2
    s_lshl_b32 s101, s4, 11
    s_add_u32 s101, s101, 16384
    v_and_b32 v19, 31, v1
    s_lshl_b32 s83, s4, 12
    s_add_u32 s83, s83, 65536
    v_lshl_add_u32 v19, v19, 7, s83
    v_mov_b32 v21, s6
    v_mov_b32 v23, s6
    v_lshrrev_b32 v17, 3, v1
    v_lshlrev_b32 v17, 12, v17
    v_and_b32 v16, 7, v1
    v_lshl_add_u32 v17, v16, 7, v17
    v_add_u32 v17, 65536, v17
    s_waitcnt lgkmcnt(0)
    v_readfirstlane_b32 s90, v4
    s_cmp_lg_u32 s90, 0
    s_nop 3
    s_cbranch_scc1 L_noqp
    s_cmp_eq_u32 s47, 0
    s_cbranch_scc1 L_nwf965
    buffer_load_dwordx2 v[20:21], v17, s[16:19], 0 offen sc1
    buffer_load_dwordx2 v[22:23], v17, s[16:19], 0 offen offset:1024 sc1
L_nwf965:
    buffer_load_dwordx4 v[8:11], v18, s[16:19], s101 offen sc1
    buffer_load_dwordx4 v[12:15], v18, s[16:19], s101 offen offset:16 sc1
    buffer_load_dwordx2 v[28:29], v19, s[16:19], 0 offen sc1
L_noqp:
    s_add_u32 s46, s81, 2101248
    s_waitcnt vmcnt(5)
    buffer_load_dwordx4 v[208:211], v3, s[12:15], s46 offen offset:0 nt
    s_add_u32 s46, s81, 2101248
    s_waitcnt vmcnt(5)
    buffer_load_dwordx4 v[212:215], v3, s[12:15], s46 offen offset:1024 nt
    s_add_u32 s46, s81, 2101248
    s_waitcnt vmcnt(5)
    buffer_load_dwordx4 v[216:219], v3, s[12:15], s46 offen offset:2048 nt
    s_add_u32 s46, s81, 2101248
    s_waitcnt vmcnt(5)
    buffer_load_dwordx4 v[220:223], v3, s[12:15], s46 offen offset:3072 nt
    s_setprio 1
    s_add_u32 s46, s81, 4194304
    s_waitcnt vmcnt(5)
    buffer_load_dwordx4 v[224:227], v3, s[12:15], s46 offen offset:0 nt
    s_add_u32 s46, s81, 4194304
    s_waitcnt vmcnt(5)
    buffer_load_dwordx4 v[228:231], v3, s[12:15], s46 offen offset:1024 nt
    s_cmp_lg_u32 s90, 0
    s_cbranch_scc1 L_waitq
    s_waitcnt vmcnt(6)
L_checkq:
    v_max3_u32 v6, v9, v9, v11
    v_min3_u32 v7, v9, v9, v11
    v_max3_u32 v6, v6, v13, v15
    v_min3_u32 v7, v7, v13, v15
    v_max3_u32 v6, v6, v29, v21
    v_min3_u32 v7, v7, v29, v21
    v_max3_u32 v6, v6, v23, s6
    v_min3_u32 v7, v7, v23, s6
    v_cmp_ne_u32 vcc, v6, v7
    s_nop 0
    s_cbranch_vccz L_gotq
    s_sleep 4
    s_cmp_eq_u32 s47, 0
    s_cbranch_scc1 L_nwf1009
    buffer_load_dwordx2 v[20:21], v17, s[16:19], 0 offen sc1
    buffer_load_dwordx2 v[22:23], v17, s[16:19], 0 offen offset:1024 sc1
L_nwf1009:
    buffer_load_dwordx4 v[8:11], v18, s[16:19], s101 offen sc1
    buffer_load_dwordx4 v[12:15], v18, s[16:19], s101 offen offset:16 sc1
    buffer_load_dwordx2 v[28:29], v19, s[16:19], 0 offen sc1
    s_waitcnt vmcnt(0)
    s_sub_u32 s7, s7, 1
    s_cbranch_scc0 L_checkq
    s_branch L_end
L_gotq:
    v_cmp_ne_u32 vcc, s91, v28
    v_mov_b32 v16, v8
    v_mov_b32 v17, v10
    v_mov_b32 v18, v12
    v_mov_b32 v19, v14
    ds_write_b128 v3, v[16:19] offset:7168
    s_cmp_eq_u64 vcc, 0
    s_cselect_b32 s41, 2, 1
    v_mov_b32 v4, s41
    s_waitcnt lgkmcnt(0)
    ds_write_b32 v5, v4 offset:16
    v_lshrrev_b32 v7, 4, v1
    v_lshlrev_b32 v6, 13, v7
    v_and_b32 v7, 15, v1
    v_lshl_add_u32 v6, v7, 8, v6
    s_lshl_b32 s83, s4, 15
    s_lshr_b32 s100, s5, 4
    s_lshl_b32 s100, s100, 12
    s_add_u32 s83, s83, s100
    s_and_b32 s100, s5, 15
    s_lshl_b32 s100, s100, 4
    s_add_u32 s83, s83, s100
    s_add_u32 s83, s83, 131072
    v_mov_b32 v28, -1
    v_mov_b32 v29, -1
    v_mov_b32 v30, -1
    v_mov_b32 v31, -1
    s_cmp_eq_u32 s41, 2
    s_nop 0
    s_cbranch_scc1 L_gs1049
    buffer_store_dwordx4 v[28:31], v6, s[16:19], s83 offen sc1
    s_nop 1
    s_branch L_gt1049
L_gs1049:
    buffer_store_dwordx4 v[28:31], v6, s[16:19], s83 offen
L_gt1049:
    s_nop 1
    s_branch L_haveq
L_waitq:
    ds_read_b32 v4, v5 offset:16
    s_waitcnt lgkmcnt(0)
    v_readfirstlane_b32 s41, v4
    s_cmp_lg_u32 s41, 0
    s_nop 3
    s_cbranch_scc1 L_readq
    s_sleep 1
    s_sub_u32 s7, s7, 1
    s_cbranch_scc0 L_waitq
    s_branch L_end
L_readq:
    ds_read_b128 v[16:19], v3 offset:7168
    s_waitcnt vmcnt(18)
    s_waitcnt lgkmcnt(0)
L_haveq:
    s_mov_b32 s100, 0x3db504f3
    v_mfma_f32_16x16x32_bf16 v[32:35], v[32:35], v[16:19], 0
    v_mfma_f32_16x16x32_bf16 v[36:39], v[36:39], v[16:19], 0
    v_mfma_f32_16x16x32_bf16 v[40:43], v[40:43], v[16:19], 0
    v_mfma_f32_16x16x32_bf16 v[44:47], v[44:47], v[16:19], 0
    v_mfma_f32_16x16x32_bf16 v[48:51], v[48:51], v[16:19], 0
    v_mfma_f32_16x16x32_bf16 v[52:55], v[52:55], v[16:19], 0
    v_mfma_f32_16x16x32_bf16 v[56:59], v[56:59], v[16:19], 0
    v_mfma_f32_16x16x32_bf16 v[60:63], v[60:63], v[16:19], 0
    s_nop 0
    v_mov_b32_dpp v20, v32 quad_perm:[0,0,0,0] row_mask:0xf bank_mask:0xf
    v_mov_b32_dpp v21, v36 quad_perm:[0,0,0,0] row_mask:0xf bank_mask:0xf
    v_mov_b32_dpp v22, v40 quad_perm:[0,0,0,0] row_mask:0xf bank_mask:0xf
    v_mov_b32_dpp v23, v44 quad_perm:[0,0,0,0] row_mask:0xf bank_mask:0xf
    v_mov_b32_dpp v24, v48 quad_perm:[0,0,0,0] row_mask:0xf bank_mask:0xf
    v_mov_b32_dpp v25, v52 quad_perm:[0,0,0,0] row_mask:0xf bank_mask:0xf
    v_mov_b32_dpp v26, v56 quad_perm:[0,0,0,0] row_mask:0xf bank_mask:0xf
    v_mov_b32_dpp v27, v60 quad_perm:[0,0,0,0] row_mask:0xf bank_mask:0xf
    v_add_f32_dpp v20, v33, v20 quad_perm:[1,1,1,1] row_mask:0xf bank_mask:0xf
    v_add_f32_dpp v21, v37, v21 quad_perm:[1,1,1,1] row_mask:0xf bank_mask:0xf
    v_add_f32_dpp v22, v41, v22 quad_perm:[1,1,1,1] row_mask:0xf bank_mask:0xf
    v_add_f32_dpp v23, v45, v23 quad_perm:[1,1,1,1] row_mask:0xf bank_mask:0xf
    v_add_f32_dpp v24, v49, v24 quad_perm:[1,1,1,1] row_mask:0xf bank_mask:0xf
    v_add_f32_dpp v25, v53, v25 quad_perm:[1,1,1,1] row_mask:0xf bank_mask:0xf
    v_add_f32_dpp v26, v57, v26 quad_perm:[1,1,1,1] row_mask:0xf bank_mask:0xf
    v_add_f32_dpp v27, v61, v27 quad_perm:[1,1,1,1] row_mask:0xf bank_mask:0xf
    v_add_f32_dpp v20, v34, v20 quad_perm:[2,2,2,2] row_mask:0xf bank_mask:0xf
    v_add_f32_dpp v21, v38, v21 quad_perm:[2,2,2,2] row_mask:0xf bank_mask:0xf
    v_add_f32_dpp v22, v42, v22 quad_perm:[2,2,2,2] row_mask:0xf bank_mask:0xf
    v_add_f32_dpp v23, v46, v23 quad_perm:[2,2,2,2] row_mask:0xf bank_mask:0xf
    v_add_f32_dpp v24, v50, v24 quad_perm:[2,2,2,2] row_mask:0xf bank_mask:0xf
    v_add_f32_dpp v25, v54, v25 quad_perm:[2,2,2,2] row_mask:0xf bank_mask:0xf
    v_add_f32_dpp v26, v58, v26 quad_perm:[2,2,2,2] row_mask:0xf bank_mask:0xf
    v_add_f32_dpp v27, v62, v27 quad_perm:[2,2,2,2] row_mask:0xf bank_mask:0xf
    v_add_f32_dpp v20, v35, v20 quad_perm:[3,3,3,3] row_mask:0xf bank_mask:0xf
    v_add_f32_dpp v21, v39, v21 quad_perm:[3,3,3,3] row_mask:0xf bank_mask:0xf
    v_add_f32_dpp v22, v43, v22 quad_perm:[3,3,3,3] row_mask:0xf bank_mask:0xf
    v_add_f32_dpp v23, v47, v23 quad_perm:[3,3,3,3] row_mask:0xf bank_mask:0xf
    v_add_f32_dpp v24, v51, v24 quad_perm:[3,3,3,3] row_mask:0xf bank_mask:0xf
    v_add_f32_dpp v25, v55, v25 quad_perm:[3,3,3,3] row_mask:0xf bank_mask:0xf
    v_add_f32_dpp v26, v59, v26 quad_perm:[3,3,3,3] row_mask:0xf bank_mask:0xf
    v_add_f32_dpp v27, v63, v27 quad_perm:[3,3,3,3] row_mask:0xf bank_mask:0xf
    s_add_u32 s46, s81, 4194304
    s_waitcnt vmcnt(5)
    buffer_load_dwordx4 v[232:235], v3, s[12:15], s46 offen offset:2048 nt
    v_cvt_pk_bf16_f32 v28, v20, v21
    v_lshlrev_b32 v20, 16, v28
    v_and_b32 v21, 0xffff0000, v28
    v_cvt_pk_bf16_f32 v29, v22, v23
    v_lshlrev_b32 v22, 16, v29
    v_and_b32 v23, 0xffff0000, v29
    v_cvt_pk_bf16_f32 v30, v24, v25
    v_lshlrev_b32 v24, 16, v30
    v_and_b32 v25, 0xffff0000, v30
    v_cvt_pk_bf16_f32 v31, v26, v27
    v_lshlrev_b32 v26, 16, v31
    v_and_b32 v27, 0xffff0000, v31
    v_mul_f32 v20, s100, v20
    v_mul_f32 v21, s100, v21
    v_mul_f32 v22, s100, v22
    v_mul_f32 v23, s100, v23
    v_mul_f32 v24, s100, v24
    v_mul_f32 v25, s100, v25
    v_mul_f32 v26, s100, v26
    v_mul_f32 v27, s100, v27
    v_cvt_pk_bf16_f32 v28, v20, v21
    v_lshlrev_b32 v20, 16, v28
    v_and_b32 v21, 0xffff0000, v28
    v_cvt_pk_bf16_f32 v29, v22, v23
    v_lshlrev_b32 v22, 16, v29
    v_and_b32 v23, 0xffff0000, v29
    v_cvt_pk_bf16_f32 v30, v24, v25
    v_lshlrev_b32 v24, 16, v30
    v_and_b32 v25, 0xffff0000, v30
    v_cvt_pk_bf16_f32 v31, v26, v27
    v_lshlrev_b32 v26, 16, v31
    v_and_b32 v27, 0xffff0000, v31
    s_add_u32 s46, s81, 4194304
    s_waitcnt vmcnt(5)
    buffer_load_dwordx4 v[236:239], v3, s[12:15], s46 offen offset:3072 nt
    v_mfma_f32_16x16x32_bf16 v[64:67], v[64:67], v[16:19], 0
    v_mfma_f32_16x16x32_bf16 v[68:71], v[68:71], v[16:19], 0
    v_mfma_f32_16x16x32_bf16 v[72:75], v[72:75], v[16:19], 0
    v_mfma_f32_16x16x32_bf16 v[76:79], v[76:79], v[16:19], 0
    v_mfma_f32_16x16x32_bf16 v[80:83], v[80:83], v[16:19], 0
    v_mfma_f32_16x16x32_bf16 v[84:87], v[84:87], v[16:19], 0
    v_mfma_f32_16x16x32_bf16 v[88:91], v[88:91], v[16:19], 0
    v_mfma_f32_16x16x32_bf16 v[92:95], v[92:95], v[16:19], 0
    s_nop 0
    v_mov_b32_dpp v64, v64 quad_perm:[0,0,0,0] row_mask:0xf bank_mask:0xf
    v_mov_b32_dpp v68, v68 quad_perm:[0,0,0,0] row_mask:0xf bank_mask:0xf
    v_mov_b32_dpp v72, v72 quad_perm:[0,0,0,0] row_mask:0xf bank_mask:0xf
    v_mov_b32_dpp v76, v76 quad_perm:[0,0,0,0] row_mask:0xf bank_mask:0xf
    v_mov_b32_dpp v80, v80 quad_perm:[0,0,0,0] row_mask:0xf bank_mask:0xf
    v_mov_b32_dpp v84, v84 quad_perm:[0,0,0,0] row_mask:0xf bank_mask:0xf
    v_mov_b32_dpp v88, v88 quad_perm:[0,0,0,0] row_mask:0xf bank_mask:0xf
    v_mov_b32_dpp v92, v92 quad_perm:[0,0,0,0] row_mask:0xf bank_mask:0xf
    v_add_f32_dpp v64, v65, v64 quad_perm:[1,1,1,1] row_mask:0xf bank_mask:0xf
    v_add_f32_dpp v68, v69, v68 quad_perm:[1,1,1,1] row_mask:0xf bank_mask:0xf
    v_add_f32_dpp v72, v73, v72 quad_perm:[1,1,1,1] row_mask:0xf bank_mask:0xf
    v_add_f32_dpp v76, v77, v76 quad_perm:[1,1,1,1] row_mask:0xf bank_mask:0xf
    v_add_f32_dpp v80, v81, v80 quad_perm:[1,1,1,1] row_mask:0xf bank_mask:0xf
    v_add_f32_dpp v84, v85, v84 quad_perm:[1,1,1,1] row_mask:0xf bank_mask:0xf
    v_add_f32_dpp v88, v89, v88 quad_perm:[1,1,1,1] row_mask:0xf bank_mask:0xf
    v_add_f32_dpp v92, v93, v92 quad_perm:[1,1,1,1] row_mask:0xf bank_mask:0xf
    v_add_f32_dpp v64, v66, v64 quad_perm:[2,2,2,2] row_mask:0xf bank_mask:0xf
    v_add_f32_dpp v68, v70, v68 quad_perm:[2,2,2,2] row_mask:0xf bank_mask:0xf
    v_add_f32_dpp v72, v74, v72 quad_perm:[2,2,2,2] row_mask:0xf bank_mask:0xf
    v_add_f32_dpp v76, v78, v76 quad_perm:[2,2,2,2] row_mask:0xf bank_mask:0xf
    v_add_f32_dpp v80, v82, v80 quad_perm:[2,2,2,2] row_mask:0xf bank_mask:0xf
    v_add_f32_dpp v84, v86, v84 quad_perm:[2,2,2,2] row_mask:0xf bank_mask:0xf
    v_add_f32_dpp v88, v90, v88 quad_perm:[2,2,2,2] row_mask:0xf bank_mask:0xf
    v_add_f32_dpp v92, v94, v92 quad_perm:[2,2,2,2] row_mask:0xf bank_mask:0xf
    v_add_f32_dpp v64, v67, v64 quad_perm:[3,3,3,3] row_mask:0xf bank_mask:0xf
    v_add_f32_dpp v68, v71, v68 quad_perm:[3,3,3,3] row_mask:0xf bank_mask:0xf
    v_add_f32_dpp v72, v75, v72 quad_perm:[3,3,3,3] row_mask:0xf bank_mask:0xf
    v_add_f32_dpp v76, v79, v76 quad_perm:[3,3,3,3] row_mask:0xf bank_mask:0xf
    v_add_f32_dpp v80, v83, v80 quad_perm:[3,3,3,3] row_mask:0xf bank_mask:0xf
    v_add_f32_dpp v84, v87, v84 quad_perm:[3,3,3,3] row_mask:0xf bank_mask:0xf
    v_add_f32_dpp v88, v91, v88 quad_perm:[3,3,3,3] row_mask:0xf bank_mask:0xf
    v_add_f32_dpp v92, v95, v92 quad_perm:[3,3,3,3] row_mask:0xf bank_mask:0xf
    s_add_u32 s46, s81, 4198400
    s_waitcnt vmcnt(5)
    buffer_load_dwordx4 v[240:243], v3, s[12:15], s46 offen offset:0 nt
    v_cvt_pk_bf16_f32 v28, v64, v68
    v_lshlrev_b32 v64, 16, v28
    v_and_b32 v68, 0xffff0000, v28
    v_cvt_pk_bf16_f32 v29, v72, v76
    v_lshlrev_b32 v72, 16, v29
    v_and_b32 v76, 0xffff0000, v29
    v_cvt_pk_bf16_f32 v30, v80, v84
    v_lshlrev_b32 v80, 16, v30
    v_and_b32 v84, 0xffff0000, v30
    v_cvt_pk_bf16_f32 v31, v88, v92
    v_lshlrev_b32 v88, 16, v31
    v_and_b32 v92, 0xffff0000, v31
    v_mul_f32 v64, s100, v64
    v_mul_f32 v68, s100, v68
    v_mul_f32 v72, s100, v72
    v_mul_f32 v76, s100, v76
    v_mul_f32 v80, s100, v80
    v_mul_f32 v84, s100, v84
    v_mul_f32 v88, s100, v88
    v_mul_f32 v92, s100, v92
    v_cvt_pk_bf16_f32 v28, v64, v68
    v_lshlrev_b32 v64, 16, v28
    v_and_b32 v68, 0xffff0000, v28
    v_cvt_pk_bf16_f32 v29, v72, v76
    v_lshlrev_b32 v72, 16, v29
    v_and_b32 v76, 0xffff0000, v29
    v_cvt_pk_bf16_f32 v30, v80, v84
    v_lshlrev_b32 v80, 16, v30
    v_and_b32 v84, 0xffff0000, v30
    v_cvt_pk_bf16_f32 v31, v88, v92
    v_lshlrev_b32 v88, 16, v31
    v_and_b32 v92, 0xffff0000, v31
    s_add_u32 s46, s81, 4198400
    s_waitcnt vmcnt(5)
    buffer_load_dwordx4 v[244:247], v3, s[12:15], s46 offen offset:1024 nt
    v_mfma_f32_16x16x32_bf16 v[96:99], v[96:99], v[16:19], 0
    v_mfma_f32_16x16x32_bf16 v[100:103], v[100:103], v[16:19], 0
    v_mfma_f32_16x16x32_bf16 v[104:107], v[104:107], v[16:19], 0
    v_mfma_f32_16x16x32_bf16 v[108:111], v[108:111], v[16:19], 0
    v_mfma_f32_16x16x32_bf16 v[112:115], v[112:115], v[16:19], 0
    v_mfma_f32_16x16x32_bf16 v[116:119], v[116:119], v[16:19], 0
    v_mfma_f32_16x16x32_bf16 v[120:123], v[120:123], v[16:19], 0
    v_mfma_f32_16x16x32_bf16 v[124:127], v[124:127], v[16:19], 0
    s_nop 0
    v_mov_b32_dpp v65, v96 quad_perm:[0,0,0,0] row_mask:0xf bank_mask:0xf
    v_mov_b32_dpp v69, v100 quad_perm:[0,0,0,0] row_mask:0xf bank_mask:0xf
    v_mov_b32_dpp v73, v104 quad_perm:[0,0,0,0] row_mask:0xf bank_mask:0xf
    v_mov_b32_dpp v77, v108 quad_perm:[0,0,0,0] row_mask:0xf bank_mask:0xf
    v_mov_b32_dpp v81, v112 quad_perm:[0,0,0,0] row_mask:0xf bank_mask:0xf
    v_mov_b32_dpp v85, v116 quad_perm:[0,0,0,0] row_mask:0xf bank_mask:0xf
    v_mov_b32_dpp v89, v120 quad_perm:[0,0,0,0] row_mask:0xf bank_mask:0xf
    v_mov_b32_dpp v93, v124 quad_perm:[0,0,0,0] row_mask:0xf bank_mask:0xf
    v_add_f32_dpp v65, v97, v65 quad_perm:[1,1,1,1] row_mask:0xf bank_mask:0xf
    v_add_f32_dpp v69, v101, v69 quad_perm:[1,1,1,1] row_mask:0xf bank_mask:0xf
    v_add_f32_dpp v73, v105, v73 quad_perm:[1,1,1,1] row_mask:0xf bank_mask:0xf
    v_add_f32_dpp v77, v109, v77 quad_perm:[1,1,1,1] row_mask:0xf bank_mask:0xf
    v_add_f32_dpp v81, v113, v81 quad_perm:[1,1,1,1] row_mask:0xf bank_mask:0xf
    v_add_f32_dpp v85, v117, v85 quad_perm:[1,1,1,1] row_mask:0xf bank_mask:0xf
    v_add_f32_dpp v89, v121, v89 quad_perm:[1,1,1,1] row_mask:0xf bank_mask:0xf
    v_add_f32_dpp v93, v125, v93 quad_perm:[1,1,1,1] row_mask:0xf bank_mask:0xf
    v_add_f32_dpp v65, v98, v65 quad_perm:[2,2,2,2] row_mask:0xf bank_mask:0xf
    v_add_f32_dpp v69, v102, v69 quad_perm:[2,2,2,2] row_mask:0xf bank_mask:0xf
    v_add_f32_dpp v73, v106, v73 quad_perm:[2,2,2,2] row_mask:0xf bank_mask:0xf
    v_add_f32_dpp v77, v110, v77 quad_perm:[2,2,2,2] row_mask:0xf bank_mask:0xf
    v_add_f32_dpp v81, v114, v81 quad_perm:[2,2,2,2] row_mask:0xf bank_mask:0xf
    v_add_f32_dpp v85, v118, v85 quad_perm:[2,2,2,2] row_mask:0xf bank_mask:0xf
    v_add_f32_dpp v89, v122, v89 quad_perm:[2,2,2,2] row_mask:0xf bank_mask:0xf
    v_add_f32_dpp v93, v126, v93 quad_perm:[2,2,2,2] row_mask:0xf bank_mask:0xf
    v_add_f32_dpp v65, v99, v65 quad_perm:[3,3,3,3] row_mask:0xf bank_mask:0xf
    v_add_f32_dpp v69, v103, v69 quad_perm:[3,3,3,3] row_mask:0xf bank_mask:0xf
    v_add_f32_dpp v73, v107, v73 quad_perm:[3,3,3,3] row_mask:0xf bank_mask:0xf
    v_add_f32_dpp v77, v111, v77 quad_perm:[3,3,3,3] row_mask:0xf bank_mask:0xf
    v_add_f32_dpp v81, v115, v81 quad_perm:[3,3,3,3] row_mask:0xf bank_mask:0xf
    v_add_f32_dpp v85, v119, v85 quad_perm:[3,3,3,3] row_mask:0xf bank_mask:0xf
    v_add_f32_dpp v89, v123, v89 quad_perm:[3,3,3,3] row_mask:0xf bank_mask:0xf
    v_add_f32_dpp v93, v127, v93 quad_perm:[3,3,3,3] row_mask:0xf bank_mask:0xf
    s_add_u32 s46, s81, 4198400
    s_waitcnt vmcnt(5)
    buffer_load_dwordx4 v[248:251], v3, s[12:15], s46 offen offset:2048 nt
    v_cvt_pk_bf16_f32 v28, v65, v69
    v_lshlrev_b32 v65, 16, v28
    v_and_b32 v69, 0xffff0000, v28
    v_cvt_pk_bf16_f32 v29, v73, v77
    v_lshlrev_b32 v73, 16, v29
    v_and_b32 v77, 0xffff0000, v29
    v_cvt_pk_bf16_f32 v30, v81, v85
    v_lshlrev_b32 v81, 16, v30
    v_and_b32 v85, 0xffff0000, v30
    v_cvt_pk_bf16_f32 v31, v89, v93
    v_lshlrev_b32 v89, 16, v31
    v_and_b32 v93, 0xffff0000, v31
    v_mul_f32 v65, s100, v65
    v_mul_f32 v69, s100, v69
    v_mul_f32 v73, s100, v73
    v_mul_f32 v77, s100, v77
    v_mul_f32 v81, s100, v81
    v_mul_f32 v85, s100, v85
    v_mul_f32 v89, s100, v89
    v_mul_f32 v93, s100, v93
    v_cvt_pk_bf16_f32 v28, v65, v69
    v_lshlrev_b32 v65, 16, v28
    v_and_b32 v69, 0xffff0000, v28
    v_cvt_pk_bf16_f32 v29, v73, v77
    v_lshlrev_b32 v73, 16, v29
    v_and_b32 v77, 0xffff0000, v29
    v_cvt_pk_bf16_f32 v30, v81, v85
    v_lshlrev_b32 v81, 16, v30
    v_and_b32 v85, 0xffff0000, v30
    v_cvt_pk_bf16_f32 v31, v89, v93
    v_lshlrev_b32 v89, 16, v31
    v_and_b32 v93, 0xffff0000, v31
    v_mfma_f32_16x16x32_bf16 v[128:131], v[128:131], v[16:19], 0
    v_mfma_f32_16x16x32_bf16 v[132:135], v[132:135], v[16:19], 0
    v_mfma_f32_16x16x32_bf16 v[136:139], v[136:139], v[16:19], 0
    v_mfma_f32_16x16x32_bf16 v[140:143], v[140:143], v[16:19], 0
    v_mfma_f32_16x16x32_bf16 v[144:147], v[144:147], v[16:19], 0
    v_mfma_f32_16x16x32_bf16 v[148:151], v[148:151], v[16:19], 0
    v_mfma_f32_16x16x32_bf16 v[152:155], v[152:155], v[16:19], 0
    v_mfma_f32_16x16x32_bf16 v[156:159], v[156:159], v[16:19], 0
    s_nop 0
    v_mov_b32_dpp v66, v128 quad_perm:[0,0,0,0] row_mask:0xf bank_mask:0xf
    v_mov_b32_dpp v70, v132 quad_perm:[0,0,0,0] row_mask:0xf bank_mask:0xf
    v_mov_b32_dpp v74, v136 quad_perm:[0,0,0,0] row_mask:0xf bank_mask:0xf
    v_mov_b32_dpp v78, v140 quad_perm:[0,0,0,0] row_mask:0xf bank_mask:0xf
    v_mov_b32_dpp v82, v144 quad_perm:[0,0,0,0] row_mask:0xf bank_mask:0xf
    v_mov_b32_dpp v86, v148 quad_perm:[0,0,0,0] row_mask:0xf bank_mask:0xf
    v_mov_b32_dpp v90, v152 quad_perm:[0,0,0,0] row_mask:0xf bank_mask:0xf
    v_mov_b32_dpp v94, v156 quad_perm:[0,0,0,0] row_mask:0xf bank_mask:0xf
    v_add_f32_dpp v66, v129, v66 quad_perm:[1,1,1,1] row_mask:0xf bank_mask:0xf
    v_add_f32_dpp v70, v133, v70 quad_perm:[1,1,1,1] row_mask:0xf bank_mask:0xf
    v_add_f32_dpp v74, v137, v74 quad_perm:[1,1,1,1] row_mask:0xf bank_mask:0xf
    v_add_f32_dpp v78, v141, v78 quad_perm:[1,1,1,1] row_mask:0xf bank_mask:0xf
    v_add_f32_dpp v82, v145, v82 quad_perm:[1,1,1,1] row_mask:0xf bank_mask:0xf
    v_add_f32_dpp v86, v149, v86 quad_perm:[1,1,1,1] row_mask:0xf bank_mask:0xf
    v_add_f32_dpp v90, v153, v90 quad_perm:[1,1,1,1] row_mask:0xf bank_mask:0xf
    v_add_f32_dpp v94, v157, v94 quad_perm:[1,1,1,1] row_mask:0xf bank_mask:0xf
    v_add_f32_dpp v66, v130, v66 quad_perm:[2,2,2,2] row_mask:0xf bank_mask:0xf
    v_add_f32_dpp v70, v134, v70 quad_perm:[2,2,2,2] row_mask:0xf bank_mask:0xf
    v_add_f32_dpp v74, v138, v74 quad_perm:[2,2,2,2] row_mask:0xf bank_mask:0xf
    v_add_f32_dpp v78, v142, v78 quad_perm:[2,2,2,2] row_mask:0xf bank_mask:0xf
    v_add_f32_dpp v82, v146, v82 quad_perm:[2,2,2,2] row_mask:0xf bank_mask:0xf
    v_add_f32_dpp v86, v150, v86 quad_perm:[2,2,2,2] row_mask:0xf bank_mask:0xf
    v_add_f32_dpp v90, v154, v90 quad_perm:[2,2,2,2] row_mask:0xf bank_mask:0xf
    v_add_f32_dpp v94, v158, v94 quad_perm:[2,2,2,2] row_mask:0xf bank_mask:0xf
    v_add_f32_dpp v66, v131, v66 quad_perm:[3,3,3,3] row_mask:0xf bank_mask:0xf
    v_add_f32_dpp v70, v135, v70 quad_perm:[3,3,3,3] row_mask:0xf bank_mask:0xf
    v_add_f32_dpp v74, v139, v74 quad_perm:[3,3,3,3] row_mask:0xf bank_mask:0xf
    v_add_f32_dpp v78, v143, v78 quad_perm:[3,3,3,3] row_mask:0xf bank_mask:0xf
    v_add_f32_dpp v82, v147, v82 quad_perm:[3,3,3,3] row_mask:0xf bank_mask:0xf
    v_add_f32_dpp v86, v151, v86 quad_perm:[3,3,3,3] row_mask:0xf bank_mask:0xf
    v_add_f32_dpp v90, v155, v90 quad_perm:[3,3,3,3] row_mask:0xf bank_mask:0xf
    v_add_f32_dpp v94, v159, v94 quad_perm:[3,3,3,3] row_mask:0xf bank_mask:0xf
    s_add_u32 s46, s81, 4198400
    s_waitcnt vmcnt(5)
    buffer_load_dwordx4 v[252:255], v3, s[12:15], s46 offen offset:3072 nt
    v_cvt_pk_bf16_f32 v28, v66, v70
    v_lshlrev_b32 v66, 16, v28
    v_and_b32 v70, 0xffff0000, v28
    v_cvt_pk_bf16_f32 v29, v74, v78
    v_lshlrev_b32 v74, 16, v29
    v_and_b32 v78, 0xffff0000, v29
    v_cvt_pk_bf16_f32 v30, v82, v86
    v_lshlrev_b32 v82, 16, v30
    v_and_b32 v86, 0xffff0000, v30
    v_cvt_pk_bf16_f32 v31, v90, v94
    v_lshlrev_b32 v90, 16, v31
    v_and_b32 v94, 0xffff0000, v31
    v_mul_f32 v66, s100, v66
    v_mul_f32 v70, s100, v70
    v_mul_f32 v74, s100, v74
    v_mul_f32 v78, s100, v78
    v_mul_f32 v82, s100, v82
    v_mul_f32 v86, s100, v86
    v_mul_f32 v90, s100, v90
    v_mul_f32 v94, s100, v94
    v_cvt_pk_bf16_f32 v28, v66, v70
    v_lshlrev_b32 v66, 16, v28
    v_and_b32 v70, 0xffff0000, v28
    v_cvt_pk_bf16_f32 v29, v74, v78
    v_lshlrev_b32 v74, 16, v29
    v_and_b32 v78, 0xffff0000, v29
    v_cvt_pk_bf16_f32 v30, v82, v86
    v_lshlrev_b32 v82, 16, v30
    v_and_b32 v86, 0xffff0000, v30
    v_cvt_pk_bf16_f32 v31, v90, v94
    v_lshlrev_b32 v90, 16, v31
    v_and_b32 v94, 0xffff0000, v31
    v_max3_f32 v6, v20, v21, v22
    v_max3_f32 v6, v6, v23, v24
    v_max3_f32 v6, v6, v25, v26
    v_max3_f32 v6, v6, v27, v64
    v_max3_f32 v6, v6, v68, v72
    v_max3_f32 v6, v6, v76, v80
    v_max3_f32 v6, v6, v84, v88
    v_max3_f32 v6, v6, v92, v65
    v_max3_f32 v6, v6, v69, v73
    v_max3_f32 v6, v6, v77, v81
    v_max3_f32 v6, v6, v85, v89
    v_max3_f32 v6, v6, v93, v66
    v_max3_f32 v6, v6, v70, v74
    v_max3_f32 v6, v6, v78, v82
    v_max3_f32 v6, v6, v86, v90
    v_max_f32 v6, v6, v94
    v_mov_b32 v28, v6
    s_nop 1
    v_permlane16_swap_b32 v6, v28
    v_max_f32 v6, v6, v28
    v_mov_b32 v28, v6
    s_nop 1
    v_permlane32_swap_b32 v6, v28
    v_max_f32 v6, v6, v28
    v_mul_f32 v6, s80, v6
    s_add_u32 s46, s81, 6291456
    s_waitcnt vmcnt(5)
    buffer_load_dwordx4 v[32:35], v3, s[12:15], s46 offen offset:0 nt
    v_fma_f32 v20, v20, s80, -v6
    v_fma_f32 v21, v21, s80, -v6
    v_fma_f32 v22, v22, s80, -v6
    v_fma_f32 v23, v23, s80, -v6
    v_fma_f32 v24, v24, s80, -v6
    v_fma_f32 v25, v25, s80, -v6
    v_fma_f32 v26, v26, s80, -v6
    v_fma_f32 v27, v27, s80, -v6
    v_fma_f32 v64, v64, s80, -v6
    v_fma_f32 v68, v68, s80, -v6
    v_fma_f32 v72, v72, s80, -v6
    v_fma_f32 v76, v76, s80, -v6
    v_fma_f32 v80, v80, s80, -v6
    v_fma_f32 v84, v84, s80, -v6
    v_fma_f32 v88, v88, s80, -v6
    v_fma_f32 v92, v92, s80, -v6
    v_fma_f32 v65, v65, s80, -v6
    v_fma_f32 v69, v69, s80, -v6
    v_fma_f32 v73, v73, s80, -v6
    v_fma_f32 v77, v77, s80, -v6
    v_fma_f32 v81, v81, s80, -v6
    v_fma_f32 v85, v85, s80, -v6
    v_fma_f32 v89, v89, s80, -v6
    v_fma_f32 v93, v93, s80, -v6
    v_fma_f32 v66, v66, s80, -v6
    v_fma_f32 v70, v70, s80, -v6
    v_fma_f32 v74, v74, s80, -v6
    v_fma_f32 v78, v78, s80, -v6
    v_fma_f32 v82, v82, s80, -v6
    v_fma_f32 v86, v86, s80, -v6
    v_fma_f32 v90, v90, s80, -v6
    v_fma_f32 v94, v94, s80, -v6
    s_add_u32 s46, s81, 6291456
    s_waitcnt vmcnt(5)
    buffer_load_dwordx4 v[36:39], v3, s[12:15], s46 offen offset:1024 nt
    v_exp_f32 v20, v20
    v_exp_f32 v21, v21
    v_exp_f32 v22, v22
    v_exp_f32 v23, v23
    v_exp_f32 v24, v24
    v_exp_f32 v25, v25
    v_exp_f32 v26, v26
    v_exp_f32 v27, v27
    v_exp_f32 v64, v64
    v_exp_f32 v68, v68
    v_exp_f32 v72, v72
    v_exp_f32 v76, v76
    v_exp_f32 v80, v80
    v_exp_f32 v84, v84
    v_exp_f32 v88, v88
    v_exp_f32 v92, v92
    v_exp_f32 v65, v65
    v_exp_f32 v69, v69
    v_exp_f32 v73, v73
    v_exp_f32 v77, v77
    v_exp_f32 v81, v81
    v_exp_f32 v85, v85
    v_exp_f32 v89, v89
    v_exp_f32 v93, v93
    v_exp_f32 v66, v66
    v_exp_f32 v70, v70
    v_exp_f32 v74, v74
    v_exp_f32 v78, v78
    v_exp_f32 v82, v82
    v_exp_f32 v86, v86
    v_exp_f32 v90, v90
    v_exp_f32 v94, v94
    s_add_u32 s46, s81, 6291456
    s_waitcnt vmcnt(5)
    buffer_load_dwordx4 v[40:43], v3, s[12:15], s46 offen offset:2048 nt
    v_add_f32 v7, v20, v21
    v_add_f32 v28, v22, v23
    v_add_f32 v7, v7, v24
    v_add_f32 v28, v28, v25
    v_add_f32 v7, v7, v26
    v_add_f32 v28, v28, v27
    v_add_f32 v7, v7, v64
    v_add_f32 v28, v28, v68
    v_add_f32 v7, v7, v72
    v_add_f32 v28, v28, v76
    v_add_f32 v7, v7, v80
    v_add_f32 v28, v28, v84
    v_add_f32 v7, v7, v88
    v_add_f32 v28, v28, v92
    v_add_f32 v7, v7, v65
    v_add_f32 v28, v28, v69
    v_add_f32 v7, v7, v73
    v_add_f32 v28, v28, v77
    v_add_f32 v7, v7, v81
    v_add_f32 v28, v28, v85
    v_add_f32 v7, v7, v89
    v_add_f32 v28, v28, v93
    v_add_f32 v7, v7, v66
    v_add_f32 v28, v28, v70
    v_add_f32 v7, v7, v74
    v_add_f32 v28, v28, v78
    v_add_f32 v7, v7, v82
    v_add_f32 v28, v28, v86
    v_add_f32 v7, v7, v90
    v_add_f32 v28, v28, v94
    v_add_f32 v7, v7, v28
    v_mov_b32 v28, v7
    s_nop 1
    v_permlane16_swap_b32 v7, v28
    v_add_f32 v7, v7, v28
    v_mov_b32 v28, v7
    s_nop 1
    v_permlane32_swap_b32 v7, v28
    v_add_f32 v7, v7, v28
    v_and_b32 v28, 12, v1
    v_lshlrev_b32 v28, 1, v28
    s_lshl_b32 s83, s3, 5
    v_add_u32 v28, s83, v28
    ds_write_b64 v28, v[6:7] offset:0
    v_mov_b32 v30, 1
    s_waitcnt vmcnt(9) lgkmcnt(0)
    s_mov_b64 exec, 1
    ds_add_rtn_u32 v30, v5, v30
    s_mov_b64 exec, -1
    v_cvt_pk_bf16_f32 v8, v20, v21
    v_cvt_pk_bf16_f32 v9, v22, v23
    v_cvt_pk_bf16_f32 v10, v24, v25
    v_cvt_pk_bf16_f32 v11, v26, v27
    v_cvt_pk_bf16_f32 v12, v64, v68
    v_cvt_pk_bf16_f32 v13, v72, v76
    v_cvt_pk_bf16_f32 v14, v80, v84
    v_cvt_pk_bf16_f32 v15, v88, v92
    v_cvt_pk_bf16_f32 v20, v65, v69
    v_cvt_pk_bf16_f32 v21, v73, v77
    v_cvt_pk_bf16_f32 v22, v81, v85
    v_cvt_pk_bf16_f32 v23, v89, v93
    v_cvt_pk_bf16_f32 v24, v66, v70
    v_cvt_pk_bf16_f32 v25, v74, v78
    v_cvt_pk_bf16_f32 v26, v82, v86
    v_cvt_pk_bf16_f32 v27, v90, v94
    s_add_u32 s46, s81, 6291456
    s_waitcnt vmcnt(5)
    buffer_load_dwordx4 v[44:47], v3, s[12:15], s46 offen offset:3072 nt
    s_waitcnt lgkmcnt(0)
    v_readfirstlane_b32 s95, v30
    s_cmp_lg_u32 s95, 7
    s_nop 3
    s_cbranch_scc1 L_nostat
    v_and_b32 v28, 31, v1
    v_lshlrev_b32 v29, 3, v28
    ds_read_b64 v[6:7], v29 offset:0
    v_and_b32 v29, 3, v28
    v_and_b32 v28, 28, v28
    v_lshl_add_u32 v28, v29, 5, v28
    v_mov_b32 v30, s5
    v_lshlrev_b32 v29, 9, v29
    v_lshl_add_u32 v29, v30, 4, v29
    s_waitcnt lgkmcnt(0)
    v_mov_b32 v16, v6
    s_nop 1
    v_max_f32_dpp v16, v16, v16 row_ror:4 row_mask:0xf bank_mask:0xf
    s_nop 1
    v_max_f32_dpp v16, v16, v16 row_ror:8 row_mask:0xf bank_mask:0xf
    v_mov_b32 v17, v16
    s_nop 1
    v_permlane16_swap_b32 v16, v17
    v_max_f32 v16, v16, v17
    v_sub_f32 v6, v6, v16
    v_exp_f32 v6, v6
    s_nop 0
    v_mul_f32 v18, v6, v7
    ds_write_b32 v28, v6 offset:384
    s_nop 0
    v_add_f32_dpp v18, v18, v18 row_ror:4 row_mask:0xf bank_mask:0xf
    s_nop 1
    v_add_f32_dpp v18, v18, v18 row_ror:8 row_mask:0xf bank_mask:0xf
    v_mov_b32 v17, v18
    s_nop 1
    v_permlane16_swap_b32 v18, v17
    v_add_f32 v18, v17, v18
    v_mov_b32 v17, s6
    v_mov_b32 v19, s6
    s_lshl_b32 s83, s4, 11
    s_add_u32 s83, s83, 32768
    s_mov_b64 exec, 15
    s_cmp_eq_u32 s41, 2
    s_cbranch_scc1 L_gs1595
    buffer_store_dwordx4 v[16:19], v29, s[16:19], s83 offen sc1
    s_nop 1
    s_branch L_gt1595
L_gs1595:
    buffer_store_dwordx4 v[16:19], v29, s[16:19], s83 offen
L_gt1595:
    s_mov_b64 exec, -1
    s_nop 0
L_nostat:
    s_add_u32 s46, s81, 6295552
    s_waitcnt vmcnt(5)
    buffer_load_dwordx4 v[48:51], v3, s[12:15], s46 offen offset:0 nt
    s_waitcnt vmcnt(21)
    v_perm_b32 v128, v164, v160, s78
    v_perm_b32 v132, v164, v160, s79
    v_perm_b32 v136, v165, v161, s78
    v_perm_b32 v140, v165, v161, s79
    v_perm_b32 v144, v166, v162, s78
    v_perm_b32 v148, v166, v162, s79
    v_perm_b32 v152, v167, v163, s78
    v_perm_b32 v156, v167, v163, s79
    v_perm_b32 v129, v172, v168, s78
    v_perm_b32 v133, v172, v168, s79
    v_perm_b32 v137, v173, v169, s78
    v_perm_b32 v141, v173, v169, s79
    v_perm_b32 v145, v174, v170, s78
    v_perm_b32 v149, v174, v170, s79
    v_perm_b32 v153, v175, v171, s78
    v_perm_b32 v157, v175, v171, s79
    v_perm_b32 v130, v180, v176, s78
    v_perm_b32 v134, v180, v176, s79
    v_perm_b32 v138, v181, v177, s78
    v_perm_b32 v142, v181, v177, s79
    v_perm_b32 v146, v182, v178, s78
    v_perm_b32 v150, v182, v178, s79
    v_perm_b32 v154, v183, v179, s78
    v_perm_b32 v158, v183, v179, s79
    v_perm_b32 v131, v188, v184, s78
    v_perm_b32 v135, v188, v184, s79
    v_perm_b32 v139, v189, v185, s78
    v_perm_b32 v143, v189, v185, s79
    v_perm_b32 v147, v190, v186, s78
    v_perm_b32 v151, v190, v186, s79
    v_perm_b32 v155, v191, v187, s78
    v_perm_b32 v159, v191, v187, s79
    v_mfma_f32_16x16x32_bf16 v[96:99], v[8:11], v[128:131], 0
    v_mfma_f32_16x16x32_bf16 v[100:103], v[8:11], v[132:135], 0
    v_mfma_f32_16x16x32_bf16 v[104:107], v[8:11], v[136:139], 0
    v_mfma_f32_16x16x32_bf16 v[108:111], v[8:11], v[140:143], 0
    v_mfma_f32_16x16x32_bf16 v[112:115], v[8:11], v[144:147], 0
    v_mfma_f32_16x16x32_bf16 v[116:119], v[8:11], v[148:151], 0
    v_mfma_f32_16x16x32_bf16 v[120:123], v[8:11], v[152:155], 0
    v_mfma_f32_16x16x32_bf16 v[124:127], v[8:11], v[156:159], 0
    s_add_u32 s46, s81, 6295552
    s_waitcnt vmcnt(5)
    buffer_load_dwordx4 v[52:55], v3, s[12:15], s46 offen offset:1024 nt
    s_waitcnt vmcnt(14)
    v_perm_b32 v128, v196, v192, s78
    v_perm_b32 v132, v196, v192, s79
    v_perm_b32 v136, v197, v193, s78
    v_perm_b32 v140, v197, v193, s79
    v_perm_b32 v144, v198, v194, s78
    v_perm_b32 v148, v198, v194, s79
    v_perm_b32 v152, v199, v195, s78
    v_perm_b32 v156, v199, v195, s79
    v_perm_b32 v129, v204, v200, s78
    v_perm_b32 v133, v204, v200, s79
    v_perm_b32 v137, v205, v201, s78
    v_perm_b32 v141, v205, v201, s79
    v_perm_b32 v145, v206, v202, s78
    v_perm_b32 v149, v206, v202, s79
    v_perm_b32 v153, v207, v203, s78
    v_perm_b32 v157, v207, v203, s79
    v_perm_b32 v130, v212, v208, s78
    v_perm_b32 v134, v212, v208, s79
    v_perm_b32 v138, v213, v209, s78
    v_perm_b32 v142, v213, v209, s79
    v_perm_b32 v146, v214, v210, s78
    v_perm_b32 v150, v214, v210, s79
    v_perm_b32 v154, v215, v211, s78
    v_perm_b32 v158, v215, v211, s79
    v_perm_b32 v131, v220, v216, s78
    v_perm_b32 v135, v220, v216, s79
    v_perm_b32 v139, v221, v217, s78
    v_perm_b32 v143, v221, v217, s79
    v_perm_b32 v147, v222, v218, s78
    v_perm_b32 v151, v222, v218, s79
    v_perm_b32 v155, v223, v219, s78
    v_perm_b32 v159, v223, v219, s79
    v_mfma_f32_16x16x32_bf16 v[96:99], v[12:15], v[128:131], v[96:99]
    v_mfma_f32_16x16x32_bf16 v[100:103], v[12:15], v[132:135], v[100:103]
    v_mfma_f32_16x16x32_bf16 v[104:107], v[12:15], v[136:139], v[104:107]
    v_mfma_f32_16x16x32_bf16 v[108:111], v[12:15], v[140:143], v[108:111]
    v_mfma_f32_16x16x32_bf16 v[112:115], v[12:15], v[144:147], v[112:115]
    v_mfma_f32_16x16x32_bf16 v[116:119], v[12:15], v[148:151], v[116:119]
    v_mfma_f32_16x16x32_bf16 v[120:123], v[12:15], v[152:155], v[120:123]
    v_mfma_f32_16x16x32_bf16 v[124:127], v[12:15], v[156:159], v[124:127]
    s_cmp_lt_u32 s5, 16
    s_cselect_b32 s95, s95, 0
    s_cmp_lg_u32 s95, 7
    s_nop 4
    s_cbranch_scc1 L_noes
    s_lshl_b32 s83, s4, 11
    s_lshr_b32 s100, s5, 3
    s_lshl_b32 s100, s100, 10
    s_add_u32 s83, s83, s100
    s_add_u32 s83, s83, 32768
    buffer_load_dwordx4 v[88:91], v3, s[16:19], s83 offen sc1
L_noes:
    s_add_u32 s46, s81, 6295552
    s_waitcnt vmcnt(5)
    buffer_load_dwordx4 v[56:59], v3, s[12:15], s46 offen offset:2048 nt
    s_add_u32 s46, s81, 6295552
    s_waitcnt vmcnt(5)
    buffer_load_dwordx4 v[60:63], v3, s[12:15], s46 offen offset:3072 nt
    s_setprio 0
    v_lshrrev_b32 v28, 3, v1
    v_and_b32 v29, 2, v28
    v_and_b32 v30, 7, v1
    v_xor_b32 v29, v30, v29
    v_lshlrev_b32 v29, 4, v29
    s_lshl_b32 s83, s4, 19
    s_lshr_b32 s100, s5, 3
    s_lshl_b32 s100, s100, 18
    s_add_u32 s83, s83, s100
    s_and_b32 s100, s5, 7
    s_lshl_b32 s100, s100, 7
    s_add_u32 s83, s83, s100
    v_lshl_add_u32 v30, v28, 10, v29
    v_xor_b32 v31, 64, v30
    s_mul_i32 s100, s3, 32768
    s_add_u32 s83, s83, s100
    s_mul_i32 s100, s3, 4096
    s_add_u32 m0, s100, 131072
    s_nop 0
    buffer_load_dwordx4 v30, s[84:87], s83 offen nt lds
    s_add_u32 s83, s83, 8192
    s_add_u32 m0, m0, 1024
    s_nop 0
    buffer_load_dwordx4 v31, s[84:87], s83 offen nt lds
    s_add_u32 s83, s83, 8192
    s_add_u32 m0, m0, 1024
    s_nop 0
    buffer_load_dwordx4 v30, s[84:87], s83 offen nt lds
    s_add_u32 s83, s83, 8192
    s_add_u32 m0, m0, 1024
    s_nop 0
    buffer_load_dwordx4 v31, s[84:87], s83 offen nt lds
L_tb1713:
    s_setprio 3
    s_waitcnt vmcnt(12)
    v_perm_b32 v128, v228, v224, s78
    v_perm_b32 v132, v228, v224, s79
    v_perm_b32 v136, v229, v225, s78
    v_perm_b32 v140, v229, v225, s79
    v_perm_b32 v144, v230, v226, s78
    v_perm_b32 v148, v230, v226, s79
    v_perm_b32 v152, v231, v227, s78
    v_perm_b32 v156, v231, v227, s79
    v_perm_b32 v129, v236, v232, s78
    v_perm_b32 v133, v236, v232, s79
    v_perm_b32 v137, v237, v233, s78
    v_perm_b32 v141, v237, v233, s79
    v_perm_b32 v145, v238, v234, s78
    v_perm_b32 v149, v238, v234, s79
    v_perm_b32 v153, v239, v235, s78
    v_perm_b32 v157, v239, v235, s79
    v_perm_b32 v130, v244, v240, s78
    v_perm_b32 v134, v244, v240, s79
    v_perm_b32 v138, v245, v241, s78
    v_perm_b32 v142, v245, v241, s79
    v_perm_b32 v146, v246, v242, s78
    v_perm_b32 v150, v246, v242, s79
    v_perm_b32 v154, v247, v243, s78
    v_perm_b32 v158, v247, v243, s79
    v_perm_b32 v131, v252, v248, s78
    v_perm_b32 v135, v252, v248, s79
    v_perm_b32 v139, v253, v249, s78
    v_perm_b32 v143, v253, v249, s79
    v_perm_b32 v147, v254, v250, s78
    v_perm_b32 v151, v254, v250, s79
    v_perm_b32 v155, v255, v251, s78
    v_perm_b32 v159, v255, v251, s79
    v_mfma_f32_16x16x32_bf16 v[96:99], v[20:23], v[128:131], v[96:99]
    v_mfma_f32_16x16x32_bf16 v[100:103], v[20:23], v[132:135], v[100:103]
    v_mfma_f32_16x16x32_bf16 v[104:107], v[20:23], v[136:139], v[104:107]
    v_mfma_f32_16x16x32_bf16 v[108:111], v[20:23], v[140:143], v[108:111]
    v_mfma_f32_16x16x32_bf16 v[112:115], v[20:23], v[144:147], v[112:115]
    v_mfma_f32_16x16x32_bf16 v[116:119], v[20:23], v[148:151], v[116:119]
    v_mfma_f32_16x16x32_bf16 v[120:123], v[20:23], v[152:155], v[120:123]
    v_mfma_f32_16x16x32_bf16 v[124:127], v[20:23], v[156:159], v[124:127]
    v_lshrrev_b32 v64, 4, v1
    v_and_b32 v65, 15, v1
    s_lshl_b32 s83, s3, 11
    v_lshlrev_b32 v74, 5, v1
    v_add_u32 v70, s83, v74
    v_lshlrev_b32 v71, 3, v0
    v_lshlrev_b32 v72, 2, v1
    s_lshl_b32 s100, s3, 5
    v_mov_b32 v76, s100
    v_bfe_u32 v29, v1, 2, 2
    v_lshl_add_u32 v30, v64, 3, v29
    v_lshlrev_b32 v30, 7, v30
    v_and_b32 v31, 3, v1
    v_lshl_add_u32 v30, v31, 3, v30
    v_bfe_u32 v29, v1, 3, 2
    v_lshl_add_u32 v30, v29, 5, v30
    s_lshl_b32 s83, s3, 12
    s_add_u32 s83, s83, 131072
    v_add_u32 v80, s83, v30
    v_xor_b32 v81, 32, v80
    v_xor_b32 v82, 64, v80
    v_xor_b32 v83, 96, v80
    s_lshl_b32 s83, s4, 2
    s_add_u32 s43, s83, s3
    s_lshl_b32 s43, s43, 13
    s_lshr_b32 s100, s5, 4
    s_lshl_b32 s100, s100, 12
    s_add_u32 s43, s43, s100
    s_and_b32 s100, s5, 15
    s_lshl_b32 s100, s100, 4
    s_add_u32 s43, s43, s100
    s_add_u32 s43, s43, 131072
    s_lshr_b32 s100, s5, 3
    s_lshl_b32 s100, s100, 1
    s_add_u32 s44, s83, s100
    s_lshr_b32 s100, s3, 2
    s_add_u32 s44, s44, s100
    s_lshl_b32 s101, s44, 9
    s_add_u32 s101, s101, 32768
    s_lshl_b32 s44, s44, 13
    s_and_b32 s100, s3, 3
    s_lshl_b32 s100, s100, 10
    s_add_u32 s44, s44, s100
    s_add_u32 s44, s44, 131072
    s_add_u32 s45, s44, 4096
    v_and_b32 v77, 31, v1
    s_lshl_b32 s100, s3, 7
    v_lshl_add_u32 v78, v77, 2, s100
    v_lshl_add_u32 v79, v64, 4, s100
    v_lshlrev_b32 v77, 4, v77
    s_lshr_b32 s100, s3, 2
    s_lshl_b32 s100, s100, 7
    v_lshl_add_u32 v95, v64, 4, s100
    v_lshrrev_b32 v73, 2, v1
    v_lshlrev_b32 v73, 8, v73
    v_and_b32 v31, 3, v1
    v_lshl_add_u32 v73, v31, 2, v73
    s_lshl_b32 s100, s3, 2
    v_add_u32 v75, s100, v74
    s_waitcnt vmcnt(8)
    v_perm_b32 v128, v36, v32, s78
    v_perm_b32 v132, v36, v32, s79
    v_perm_b32 v136, v37, v33, s78
    v_perm_b32 v140, v37, v33, s79
    v_perm_b32 v144, v38, v34, s78
    v_perm_b32 v148, v38, v34, s79
    v_perm_b32 v152, v39, v35, s78
    v_perm_b32 v156, v39, v35, s79
    v_perm_b32 v129, v44, v40, s78
    v_perm_b32 v133, v44, v40, s79
    v_perm_b32 v137, v45, v41, s78
    v_perm_b32 v141, v45, v41, s79
    v_perm_b32 v145, v46, v42, s78
    v_perm_b32 v149, v46, v42, s79
    v_perm_b32 v153, v47, v43, s78
    v_perm_b32 v157, v47, v43, s79
    s_waitcnt vmcnt(6)
    v_perm_b32 v130, v52, v48, s78
    v_perm_b32 v134, v52, v48, s79
    v_perm_b32 v138, v53, v49, s78
    v_perm_b32 v142, v53, v49, s79
    v_perm_b32 v146, v54, v50, s78
    v_perm_b32 v150, v54, v50, s79
    v_perm_b32 v154, v55, v51, s78
    v_perm_b32 v158, v55, v51, s79
    s_cmp_lg_u32 s95, 7
    s_nop 0
    s_cbranch_scc1 L_noew
    v_max3_u32 v6, v89, v91, s6
    v_min3_u32 v7, v89, v91, s6
    v_cmp_ne_u32 vcc, v6, v7
    s_nop 0
    s_cbranch_vccnz L_noew
    v_mov_b32 v28, v88
    s_nop 1
    v_max_f32_dpp v28, v28, v28 row_ror:1 row_mask:0xf bank_mask:0xf
    s_nop 1
    v_max_f32_dpp v28, v28, v28 row_ror:2 row_mask:0xf bank_mask:0xf
    s_nop 1
    v_max_f32_dpp v28, v28, v28 row_ror:4 row_mask:0xf bank_mask:0xf
    s_nop 1
    v_max_f32_dpp v28, v28, v28 row_ror:8 row_mask:0xf bank_mask:0xf
    v_mov_b32 v29, v28
    s_nop 1
    v_permlane16_swap_b32 v28, v29
    v_max_f32 v28, v28, v29
    v_sub_f32 v88, v88, v28
    v_exp_f32 v88, v88
    s_nop 0
    v_mul_f32 v28, v88, v90
    s_nop 1
    v_add_f32_dpp v28, v28, v28 row_ror:1 row_mask:0xf bank_mask:0xf
    s_nop 1
    v_add_f32_dpp v28, v28, v28 row_ror:2 row_mask:0xf bank_mask:0xf
    s_nop 1
    v_add_f32_dpp v28, v28, v28 row_ror:4 row_mask:0xf bank_mask:0xf
    s_nop 1
    v_add_f32_dpp v28, v28, v28 row_ror:8 row_mask:0xf bank_mask:0xf
    v_mov_b32 v29, v28
    s_nop 1
    v_permlane16_swap_b32 v28, v29
    v_add_f32 v28, v28, v29
    v_rcp_f32 v28, v28
    s_nop 0
    v_mul_f32 v28, v28, v88
    ds_write_b32 v72, v28 offset:1536
    ds_write_b32 v5, v5 offset:8
L_noew:
    s_waitcnt vmcnt(4)
    v_perm_b32 v131, v60, v56, s78
    v_perm_b32 v135, v60, v56, s79
    v_perm_b32 v139, v61, v57, s78
    v_perm_b32 v143, v61, v57, s79
    v_perm_b32 v147, v62, v58, s78
    v_perm_b32 v151, v62, v58, s79
    v_perm_b32 v155, v63, v59, s78
    v_perm_b32 v159, v63, v59, s79
    v_mfma_f32_16x16x32_bf16 v[96:99], v[24:27], v[128:131], v[96:99]
    v_mfma_f32_16x16x32_bf16 v[100:103], v[24:27], v[132:135], v[100:103]
    v_mfma_f32_16x16x32_bf16 v[104:107], v[24:27], v[136:139], v[104:107]
    v_mfma_f32_16x16x32_bf16 v[108:111], v[24:27], v[140:143], v[108:111]
    v_mfma_f32_16x16x32_bf16 v[112:115], v[24:27], v[144:147], v[112:115]
    v_mfma_f32_16x16x32_bf16 v[116:119], v[24:27], v[148:151], v[116:119]
    v_mfma_f32_16x16x32_bf16 v[120:123], v[24:27], v[152:155], v[120:123]
    v_mfma_f32_16x16x32_bf16 v[124:127], v[24:27], v[156:159], v[124:127]
    s_nop 0
    v_mov_b32 v208, v96
    v_mov_b32 v209, v100
    v_mov_b32 v210, v104
    v_mov_b32 v211, v108
    v_mov_b32 v212, v112
    v_mov_b32 v213, v116
    v_mov_b32 v214, v120
    v_mov_b32 v215, v124
    ds_write_b128 v70, v[208:211] offset:8192
    ds_write_b128 v70, v[212:215] offset:8208
    s_waitcnt lgkmcnt(0)
    s_barrier
    s_cmp_ge_u32 s3, 4
    s_cbranch_scc1 L_nopart
    ds_read_b128 v[112:115], v76 offset:384
    ds_read_b128 v[116:119], v76 offset:400
    ds_read_b64 v[96:97], v71 offset:8192
    ds_read_b64 v[98:99], v71 offset:10240
    ds_read_b64 v[100:101], v71 offset:12288
    ds_read_b64 v[102:103], v71 offset:14336
    ds_read_b64 v[104:105], v71 offset:16384
    ds_read_b64 v[106:107], v71 offset:18432
    ds_read_b64 v[108:109], v71 offset:20480
    ds_read_b64 v[110:111], v71 offset:22528
    s_waitcnt lgkmcnt(6)
    v_mul_f32 v208, v96, v112
    v_mul_f32 v209, v97, v112
    v_mul_f32 v210, v98, v113
    v_mul_f32 v211, v99, v113
    s_waitcnt lgkmcnt(4)
    v_fmac_f32 v208, v100, v114
    v_fmac_f32 v209, v101, v114
    v_fmac_f32 v210, v102, v115
    v_fmac_f32 v211, v103, v115
    s_waitcnt lgkmcnt(2)
    v_fmac_f32 v208, v104, v116
    v_fmac_f32 v209, v105, v116
    v_fmac_f32 v210, v106, v117
    v_fmac_f32 v211, v107, v117
    s_waitcnt lgkmcnt(0)
    v_fmac_f32 v208, v108, v118
    v_fmac_f32 v209, v109, v118
    v_fmac_f32 v210, v110, v119
    v_fmac_f32 v211, v111, v119
    v_pk_add_f32 v[208:209], v[208:209], v[210:211]
    v_cvt_pk_bf16_f32 v208, v208, v209
    v_min_u32 v208, -2, v208
    s_cmp_eq_u32 s41, 2
    s_nop 0
    s_cbranch_scc1 L_gs1981
    buffer_store_dword v208, v73, s[16:19], s43 offen sc1
    s_branch L_gt1981
L_gs1981:
    buffer_store_dword v208, v73, s[16:19], s43 offen
L_gt1981:
L_nopart:
    s_cmp_lg_u32 s47, 0
    s_cbranch_scc1 L_stageb
    s_sub_u32 s96, s5, 16
    s_cmp_ge_u32 s96, 8
    s_cbranch_scc1 L_nopf2
    v_lshrrev_b32 v28, 5, v1
    v_mul_u32_u24 v28, 3584, v28
    v_and_b32 v29, 31, v1
    v_lshl_add_u32 v28, v29, 4, v28
    s_lshl_b32 s96, s96, 3
    s_add_u32 s96, s96, s3
    s_mul_i32 s83, s96, 28672
    s_mul_i32 s100, s4, 448
    s_and_b32 s100, s100, 0xffffff80
    s_add_u32 s83, s83, s100
    s_mov_b32 m0, 131072
    s_nop 0
    buffer_load_dwordx4 v28, s[20:23], s83 offen lds
    s_add_u32 s83, s83, 7168
    buffer_load_dwordx4 v28, s[20:23], s83 offen lds
    s_add_u32 s83, s83, 7168
    buffer_load_dwordx4 v28, s[20:23], s83 offen lds
    s_add_u32 s83, s83, 7168
    buffer_load_dwordx4 v28, s[20:23], s83 offen lds
L_nopf2:
    s_cmp_ge_u32 s5, 16
    s_cbranch_scc1 L_fin
    ds_read_b32 v28, v5 offset:8
    ds_read_b128 v[192:195], v95 offset:1536
    ds_read_b128 v[196:199], v95 offset:1600
    s_waitcnt lgkmcnt(0)
    v_readfirstlane_b32 s83, v28
    s_cmp_lg_u32 s83, 0
    s_nop 3
    s_cbranch_scc1 L_havew
L_statchk:
    buffer_load_dwordx4 v[88:91], v77, s[16:19], s101 offen sc1
    s_waitcnt vmcnt(0)
    v_max3_u32 v6, v89, v91, s6
    v_min3_u32 v7, v89, v91, s6
    v_cmp_ne_u32 vcc, v6, v7
    s_nop 0
    s_cbranch_vccz L_gotstat
    s_sleep 2
    s_sub_u32 s7, s7, 1
    s_cbranch_scc0 L_statchk
    s_branch L_end
L_gotstat:
    v_mov_b32 v28, v88
    s_nop 1
    v_max_f32_dpp v28, v28, v28 row_ror:1 row_mask:0xf bank_mask:0xf
    s_nop 1
    v_max_f32_dpp v28, v28, v28 row_ror:2 row_mask:0xf bank_mask:0xf
    s_nop 1
    v_max_f32_dpp v28, v28, v28 row_ror:4 row_mask:0xf bank_mask:0xf
    s_nop 1
    v_max_f32_dpp v28, v28, v28 row_ror:8 row_mask:0xf bank_mask:0xf
    v_mov_b32 v29, v28
    s_nop 1
    v_permlane16_swap_b32 v28, v29
    v_max_f32 v28, v28, v29
    v_sub_f32 v88, v88, v28
    v_exp_f32 v88, v88
    s_nop 0
    v_mul_f32 v28, v88, v90
    s_nop 1
    v_add_f32_dpp v28, v28, v28 row_ror:1 row_mask:0xf bank_mask:0xf
    s_nop 1
    v_add_f32_dpp v28, v28, v28 row_ror:2 row_mask:0xf bank_mask:0xf
    s_nop 1
    v_add_f32_dpp v28, v28, v28 row_ror:4 row_mask:0xf bank_mask:0xf
    s_nop 1
    v_add_f32_dpp v28, v28, v28 row_ror:8 row_mask:0xf bank_mask:0xf
    v_mov_b32 v29, v28
    s_nop 1
    v_permlane16_swap_b32 v28, v29
    v_add_f32 v28, v28, v29
    v_rcp_f32 v28, v28
    s_nop 0
    v_mul_f32 v28, v28, v88
    ds_write_b32 v78, v28 offset:512
    s_waitcnt lgkmcnt(0)
    ds_read_b128 v[192:195], v79 offset:512
    ds_read_b128 v[196:199], v79 offset:576
L_havew:
    buffer_load_dwordx4 v[128:131], v3, s[16:19], s44 offen sc1
    buffer_load_dwordx4 v[132:135], v3, s[16:19], s45 offen sc1
    s_waitcnt vmcnt(2)
    ds_read_b64_tr_b16 v[160:161], v80 offset:0
    ds_read_b64_tr_b16 v[162:163], v80 offset:512
    ds_read_b64_tr_b16 v[164:165], v81 offset:0
    ds_read_b64_tr_b16 v[166:167], v81 offset:512
    ds_read_b64_tr_b16 v[168:169], v82 offset:0
    ds_read_b64_tr_b16 v[170:171], v82 offset:512
    ds_read_b64_tr_b16 v[172:173], v83 offset:0
    ds_read_b64_tr_b16 v[174:175], v83 offset:512
L_qpa:
    s_waitcnt vmcnt(0)
    v_cmp_eq_u32 s[8:9], -1, v128
    v_cmp_eq_u32 s[10:11], -1, v132
    s_nop 0
    s_or_b64 vcc, s[8:9], s[10:11]
    s_cbranch_scc0 L_polla
    s_mov_b64 exec, s[8:9]
    buffer_load_dwordx4 v[128:131], v3, s[16:19], s44 offen sc1
    s_mov_b64 exec, s[10:11]
    buffer_load_dwordx4 v[132:135], v3, s[16:19], s45 offen sc1
    s_mov_b64 exec, -1
    s_sub_u32 s7, s7, 1
    s_cbranch_scc0 L_qpa
    s_branch L_end
L_polla:
    s_waitcnt vmcnt(0)
    v_max3_u32 v28, v128, v129, v130
    v_max_u32 v28, v28, v131
    v_max3_u32 v29, v132, v133, v134
    v_max_u32 v29, v29, v135
    v_max_u32 v6, v28, v29
    v_cmp_eq_u32 vcc, -1, v6
    s_nop 0
    s_cbranch_vccz L_gota
    v_cmp_eq_u32 vcc, -1, v28
    s_nop 0
    s_mov_b64 exec, vcc
    buffer_load_dwordx4 v[128:131], v3, s[16:19], s44 offen sc1
    s_mov_b64 exec, -1
    v_cmp_eq_u32 vcc, -1, v29
    s_nop 0
    s_mov_b64 exec, vcc
    buffer_load_dwordx4 v[132:135], v3, s[16:19], s45 offen sc1
    s_mov_b64 exec, -1
    s_sub_u32 s7, s7, 1
    s_cbranch_scc0 L_polla
    s_branch L_end
L_gota:
    s_waitcnt lgkmcnt(0)
    v_mfma_f32_16x16x32_bf16 v[96:99], v[128:131], v[160:163], 0
    v_mfma_f32_16x16x32_bf16 v[100:103], v[128:131], v[164:167], 0
    v_mfma_f32_16x16x32_bf16 v[104:107], v[128:131], v[168:171], 0
    v_mfma_f32_16x16x32_bf16 v[108:111], v[128:131], v[172:175], 0
    v_mfma_f32_16x16x32_bf16 v[112:115], v[132:135], v[160:163], 0
    v_mfma_f32_16x16x32_bf16 v[116:119], v[132:135], v[164:167], 0
    v_mfma_f32_16x16x32_bf16 v[120:123], v[132:135], v[168:171], 0
    v_mfma_f32_16x16x32_bf16 v[124:127], v[132:135], v[172:175], 0
    s_nop 0
    v_pk_mul_f32 v[96:97], v[96:97], v[192:193]
    v_pk_mul_f32 v[100:101], v[100:101], v[192:193]
    v_pk_mul_f32 v[104:105], v[104:105], v[192:193]
    v_pk_mul_f32 v[108:109], v[108:109], v[192:193]
    v_pk_fma_f32 v[96:97], v[98:99], v[194:195], v[96:97]
    v_pk_fma_f32 v[100:101], v[102:103], v[194:195], v[100:101]
    v_pk_fma_f32 v[104:105], v[106:107], v[194:195], v[104:105]
    v_pk_fma_f32 v[108:109], v[110:111], v[194:195], v[108:109]
    v_pk_fma_f32 v[96:97], v[112:113], v[196:197], v[96:97]
    v_pk_fma_f32 v[100:101], v[116:117], v[196:197], v[100:101]
    v_pk_fma_f32 v[104:105], v[120:121], v[196:197], v[104:105]
    v_pk_fma_f32 v[108:109], v[124:125], v[196:197], v[108:109]
    v_pk_fma_f32 v[96:97], v[114:115], v[198:199], v[96:97]
    v_pk_fma_f32 v[100:101], v[118:119], v[198:199], v[100:101]
    v_pk_fma_f32 v[104:105], v[122:123], v[198:199], v[104:105]
    v_pk_fma_f32 v[108:109], v[126:127], v[198:199], v[108:109]
    v_add_f32 v96, v96, v97
    v_add_f32 v100, v100, v101
    v_add_f32 v104, v104, v105
    v_add_f32 v108, v108, v109
    v_permlane16_swap_b32 v96, v100
    s_nop 0
    v_permlane16_swap_b32 v104, v108
    v_add_f32 v96, v96, v100
    v_add_f32 v104, v104, v108
    s_nop 1
    v_permlane32_swap_b32 v96, v104
    v_add_f32 v96, v96, v104
    ds_write_b32 v75, v96 offset:4096
    s_waitcnt lgkmcnt(0)
    s_barrier
    s_cmp_lg_u32 s3, 0
    s_cbranch_scc1 L_fin
    ds_read_b128 v[208:211], v74 offset:4096
    ds_read_b128 v[212:215], v74 offset:4112
    s_waitcnt lgkmcnt(0)
    v_pk_add_f32 v[208:209], v[208:209], v[212:213]
    v_pk_add_f32 v[210:211], v[210:211], v[214:215]
    v_pk_add_f32 v[208:209], v[208:209], v[210:211]
    v_add_f32 v208, v208, v209
    v_min_u32 v208, -2, v208
    buffer_store_dword v208, v72, s[16:19], s92 offen sc1
    s_nop 0
    s_branch L_fin
L_stageb:
    v_lshrrev_b32 v28, 3, v1
    v_and_b32 v29, 7, v1
    v_lshlrev_b32 v29, 4, v29
    v_lshl_add_u32 v28, v28, 10, v29
    s_lshl_b32 s83, s82, 15
    s_lshl_b32 s100, s3, 7
    s_add_u32 s83, s83, s100
    s_lshl_b32 s96, s3, 13
    s_add_u32 m0, s96, 69632
    s_nop 0
    buffer_load_dwordx4 v28, s[24:27], s83 offen nt lds
    s_add_u32 s83, s83, 8192
    s_add_u32 m0, m0, 1024
    s_nop 0
    buffer_load_dwordx4 v28, s[24:27], s83 offen nt lds
    s_add_u32 s83, s83, 8192
    s_add_u32 m0, m0, 1024
    s_nop 0
    buffer_load_dwordx4 v28, s[24:27], s83 offen nt lds
    s_add_u32 s83, s83, 8192
    s_add_u32 m0, m0, 1024
    s_nop 0
    buffer_load_dwordx4 v28, s[24:27], s83 offen nt lds
    v_lshrrev_b32 v28, 2, v1
    v_mul_u32_u24 v28, 3584, v28
    v_and_b32 v29, 3, v1
    v_lshl_add_u32 v28, v29, 4, v28
    s_mul_i32 s83, s3, 57344
    s_lshl_b32 s100, s82, 6
    s_add_u32 s83, s83, s100
    s_lshl_b32 s96, s3, 13
    s_add_u32 m0, s96, 65536
    s_nop 0
    buffer_load_dwordx4 v28, s[20:23], s83 offen  lds
    s_add_u32 s83, s83, 458752
    s_add_u32 m0, m0, 1024
    s_nop 0
    buffer_load_dwordx4 v28, s[20:23], s83 offen  lds
    s_add_u32 s83, s83, 458752
    s_add_u32 m0, m0, 1024
    s_nop 0
    buffer_load_dwordx4 v28, s[20:23], s83 offen  lds
    s_add_u32 s83, s83, 458752
    s_add_u32 m0, m0, 1024
    s_nop 0
    buffer_load_dwordx4 v28, s[20:23], s83 offen  lds
L_now1:
    v_lshlrev_b32 v77, 11, v64
    v_lshl_add_u32 v77, v65, 4, v77
    s_lshl_b32 s83, s3, 8
    s_add_u32 s88, s83, 1048576
    s_add_u32 s89, s83, 1056768
    s_add_u32 s90, s83, 1064960
    s_add_u32 s95, s83, 1073152
    v_lshl_add_u32 v66, v65, 2, v64
    s_lshl_b32 s83, s3, 6
    v_add_u32 v66, s83, v66
    v_lshlrev_b32 v67, 1, v66
    buffer_load_ushort v94, v67, s[28:31], 0 offen
    v_and_b32 v67, 0x1fe, v66
    v_lshlrev_b32 v67, 2, v67
    s_mul_i32 s98, s3, 56
    s_add_u32 s98, s98, s82
    s_lshl_b32 s99, s98, 4
    s_and_b32 s99, s99, 0x7ff
    v_mov_b32 v69, s99
    s_lshl_b32 s83, s3, 2
    v_add_u32 v68, s83, v65
    v_and_b32 v68, 15, v68
    v_lshl_add_u32 v68, v64, 4, v68
    v_lshlrev_b32 v68, 5, v68
    ds_read_b64 v[84:85], v67 offset:24576
    ds_read_b128 v[232:235], v68 offset:26624
    ds_read_b128 v[236:239], v68 offset:26640
    ds_read_b128 v[240:243], v68 offset:28672
    ds_read_b128 v[244:247], v68 offset:28688
    ds_read_b128 v[88:91], v69 offset:30720
    s_lshl_b32 s96, s3, 13
    s_add_u32 s96, s96, 65536
    v_bfe_u32 v28, v1, 2, 2
    v_and_b32 v29, 3, v1
    v_lshlrev_b32 v29, 3, v29
    v_lshl_add_u32 v30, v28, 6, v29
    v_lshl_add_u32 v30, v64, 10, v30
    s_and_b32 s100, s3, 3
    s_lshl_b32 s100, s100, 14
    s_add_u32 s100, s100, 65536
    v_add_u32 v30, s100, v30
    v_lshl_add_u32 v28, v28, 7, v29
    v_lshl_add_u32 v28, v64, 5, v28
    v_add_u32 v28, s96, v28
    v_lshlrev_b32 v74, 5, v65
    v_lshlrev_b32 v75, 4, v65
    s_lshl_b32 s100, s3, 2
    v_add_u32 v75, s100, v75
    v_lshlrev_b32 v73, 2, v0
    v_mov_b32 v79, 0
    s_waitcnt lgkmcnt(0)
    s_nop 0
L_modchk:
    v_max3_u32 v6, v85, v85, v89
    v_min3_u32 v7, v85, v85, v89
    v_max3_u32 v6, v6, v91, v233
    v_min3_u32 v7, v7, v91, v233
    v_max3_u32 v6, v6, v235, v237
    v_min3_u32 v7, v7, v235, v237
    v_max3_u32 v6, v6, v239, v241
    v_min3_u32 v7, v7, v239, v241
    v_max3_u32 v6, v6, v243, v245
    v_min3_u32 v7, v7, v243, v245
    v_max3_u32 v6, v6, v247, s6
    v_min3_u32 v7, v7, v247, s6
    v_cmp_ne_u32 vcc, v6, v7
    s_nop 0
    s_cbranch_vccz L_gotmd
    s_mov_b32 s83, 8192
    buffer_load_dwordx2 v[84:85], v67, s[16:19], s83 offen sc1
    buffer_load_dwordx4 v[232:235], v68, s[16:19], s83 offen offset:2048 sc1
    buffer_load_dwordx4 v[236:239], v68, s[16:19], s83 offen offset:2064 sc1
    s_mov_b32 s83, 12288
    buffer_load_dwordx4 v[240:243], v68, s[16:19], s83 offen sc1
    buffer_load_dwordx4 v[244:247], v68, s[16:19], s83 offen offset:16 sc1
    buffer_load_dwordx4 v[88:91], v69, s[16:19], s83 offen offset:2048 sc1
    s_waitcnt vmcnt(0)
    s_sub_u32 s7, s7, 1
    s_cbranch_scc0 L_modchk
    s_branch L_end
L_gotmd:
    v_and_b32 v6, 1, v66
    v_lshlrev_b32 v66, 2, v66
    v_cmp_eq_u32 vcc, 0, v6
    v_lshlrev_b32 v6, 16, v84
    v_and_b32 v7, 0xffff0000, v84
    v_cndmask_b32 v84, v7, v6, vcc
    v_lshlrev_b32 v200, 16, v232
    v_and_b32 v201, 0xffff0000, v232
    v_lshlrev_b32 v192, 16, v240
    v_and_b32 v193, 0xffff0000, v240
    v_add_f32 v192, 1.0, v192
    v_add_f32 v193, 1.0, v193
    v_cvt_pk_bf16_f32 v6, v192, v193
    v_lshlrev_b32 v192, 16, v6
    v_and_b32 v193, 0xffff0000, v6
    v_lshlrev_b32 v202, 16, v234
    v_and_b32 v203, 0xffff0000, v234
    v_lshlrev_b32 v194, 16, v242
    v_and_b32 v195, 0xffff0000, v242
    v_add_f32 v194, 1.0, v194
    v_add_f32 v195, 1.0, v195
    v_cvt_pk_bf16_f32 v6, v194, v195
    v_lshlrev_b32 v194, 16, v6
    v_and_b32 v195, 0xffff0000, v6
    v_lshlrev_b32 v204, 16, v236
    v_and_b32 v205, 0xffff0000, v236
    v_lshlrev_b32 v196, 16, v244
    v_and_b32 v197, 0xffff0000, v244
    v_add_f32 v196, 1.0, v196
    v_add_f32 v197, 1.0, v197
    v_cvt_pk_bf16_f32 v6, v196, v197
    v_lshlrev_b32 v196, 16, v6
    v_and_b32 v197, 0xffff0000, v6
    v_lshlrev_b32 v206, 16, v238
    v_and_b32 v207, 0xffff0000, v238
    v_lshlrev_b32 v198, 16, v246
    v_and_b32 v199, 0xffff0000, v246
    v_add_f32 v198, 1.0, v198
    v_add_f32 v199, 1.0, v199
    v_cvt_pk_bf16_f32 v6, v198, v199
    v_lshlrev_b32 v198, 16, v6
    v_and_b32 v199, 0xffff0000, v6
    v_lshlrev_b32 v224, 16, v88
    v_and_b32 v225, 0xffff0000, v88
    v_lshlrev_b32 v226, 16, v90
    v_and_b32 v227, 0xffff0000, v90
    v_mov_b32_dpp v224, v225 quad_perm:[0,1,2,3] row_mask:0x2 bank_mask:0xf
    v_mov_b32_dpp v224, v226 quad_perm:[0,1,2,3] row_mask:0x4 bank_mask:0xf
    v_mov_b32_dpp v224, v227 quad_perm:[0,1,2,3] row_mask:0x8 bank_mask:0xf
    v_lshl_add_u32 v69, v64, 2, v69
    s_waitcnt vmcnt(0)
    buffer_load_dwordx4 v[128:131], v77, s[16:19], s88 offen sc1
    buffer_load_dwordx4 v[132:135], v77, s[16:19], s89 offen sc1
    buffer_load_dwordx4 v[136:139], v77, s[16:19], s90 offen sc1
    buffer_load_dwordx4 v[140:143], v77, s[16:19], s95 offen sc1
    s_barrier
    ds_read_b64_tr_b16 v[160:161], v30 offset:0
    ds_read_b64_tr_b16 v[162:163], v30 offset:256
    ds_read_b64_tr_b16 v[164:165], v30 offset:512
    ds_read_b64_tr_b16 v[166:167], v30 offset:768
    ds_read_b64_tr_b16 v[168:169], v30 offset:8192
    ds_read_b64_tr_b16 v[170:171], v30 offset:8448
    ds_read_b64_tr_b16 v[172:173], v30 offset:8704
    ds_read_b64_tr_b16 v[174:175], v30 offset:8960
    ds_read_b64_tr_b16 v[176:177], v30 offset:32
    ds_read_b64_tr_b16 v[178:179], v30 offset:288
    ds_read_b64_tr_b16 v[180:181], v30 offset:544
    ds_read_b64_tr_b16 v[182:183], v30 offset:800
    ds_read_b64_tr_b16 v[184:185], v30 offset:8224
    ds_read_b64_tr_b16 v[186:187], v30 offset:8480
    ds_read_b64_tr_b16 v[188:189], v30 offset:8736
    ds_read_b64_tr_b16 v[190:191], v30 offset:8992
    ds_read_b64_tr_b16 v[144:145], v28 offset:4096
    ds_read_b64_tr_b16 v[146:147], v28 offset:4608
    ds_read_b64_tr_b16 v[148:149], v28 offset:5120
    ds_read_b64_tr_b16 v[150:151], v28 offset:5632
    ds_read_b64_tr_b16 v[152:153], v28 offset:6144
    ds_read_b64_tr_b16 v[154:155], v28 offset:6656
    ds_read_b64_tr_b16 v[156:157], v28 offset:7168
    ds_read_b64_tr_b16 v[158:159], v28 offset:7680
    v_lshlrev_b32 v94, 16, v94
    s_nop 1
L_qpb:
    s_waitcnt vmcnt(0)
    v_cmp_eq_u32 s[8:9], -1, v128
    v_cmp_eq_u32 s[10:11], -1, v132
    v_cmp_eq_u32 s[12:13], -1, v136
    v_cmp_eq_u32 s[14:15], -1, v140
    s_or_b64 vcc, s[8:9], s[10:11]
    s_or_b64 vcc, vcc, s[12:13]
    s_or_b64 vcc, vcc, s[14:15]
    s_cbranch_scc0 L_pollb
    s_mov_b64 exec, s[8:9]
    buffer_load_dwordx4 v[128:131], v77, s[16:19], s88 offen sc1
    s_mov_b64 exec, s[10:11]
    buffer_load_dwordx4 v[132:135], v77, s[16:19], s89 offen sc1
    s_mov_b64 exec, s[12:13]
    buffer_load_dwordx4 v[136:139], v77, s[16:19], s90 offen sc1
    s_mov_b64 exec, s[14:15]
    buffer_load_dwordx4 v[140:143], v77, s[16:19], s95 offen sc1
    s_mov_b64 exec, -1
    s_sub_u32 s7, s7, 1
    s_cbranch_scc0 L_qpb
    s_branch L_end
L_pollb:
    s_waitcnt vmcnt(0)
    v_pk_add_f32 v[32:33], v[128:129], v[136:137]
    v_pk_add_f32 v[34:35], v[130:131], v[138:139]
    v_pk_add_f32 v[36:37], v[132:133], v[140:141]
    v_pk_add_f32 v[38:39], v[134:135], v[142:143]
    v_pk_add_f32 v[32:33], v[32:33], v[36:37]
    v_pk_add_f32 v[34:35], v[34:35], v[38:39]
    v_pk_add_f32 v[36:37], v[32:33], v[34:35]
    v_cmp_u_f32 vcc, v36, v37
    s_nop 0
    s_cbranch_vccz L_gotb
    v_max3_u32 v16, v128, v129, v130
    v_max_u32 v16, v16, v131
    v_max3_u32 v17, v132, v133, v134
    v_max_u32 v17, v17, v135
    v_max3_u32 v18, v136, v137, v138
    v_max_u32 v18, v18, v139
    v_max3_u32 v19, v140, v141, v142
    v_max_u32 v19, v19, v143
    v_max3_u32 v6, v16, v17, v18
    v_max_u32 v6, v6, v19
    v_cmp_eq_u32 vcc, -1, v6
    s_nop 0
    s_cbranch_vccz L_gotb
    v_cmp_eq_u32 vcc, -1, v16
    s_nop 0
    s_mov_b64 exec, vcc
    buffer_load_dwordx4 v[128:131], v77, s[16:19], s88 offen sc1
    s_mov_b64 exec, -1
    v_cmp_eq_u32 vcc, -1, v17
    s_nop 0
    s_mov_b64 exec, vcc
    buffer_load_dwordx4 v[132:135], v77, s[16:19], s89 offen sc1
    s_mov_b64 exec, -1
    v_cmp_eq_u32 vcc, -1, v18
    s_nop 0
    s_mov_b64 exec, vcc
    buffer_load_dwordx4 v[136:139], v77, s[16:19], s90 offen sc1
    s_mov_b64 exec, -1
    v_cmp_eq_u32 vcc, -1, v19
    s_nop 0
    s_mov_b64 exec, vcc
    buffer_load_dwordx4 v[140:143], v77, s[16:19], s95 offen sc1
    s_mov_b64 exec, -1
    s_sub_u32 s7, s7, 1
    s_cbranch_scc0 L_pollb
    s_branch L_end
L_gotb:
    v_permlane16_swap_b32 v32, v33
    v_permlane16_swap_b32 v34, v35
    v_add_f32 v32, v32, v33
    v_add_f32 v34, v34, v35
    s_nop 1
    v_permlane32_swap_b32 v32, v34
    v_add_f32 v32, v32, v34
    v_cvt_pk_bf16_f32 v32, v32, v32
    v_lshlrev_b32 v32, 16, v32
    v_mul_f32 v32, v32, v84
    v_cvt_pk_bf16_f32 v32, v32, v32
    v_lshlrev_b32 v32, 16, v32
    v_add_f32 v32, v32, v94
    v_cvt_pk_bf16_f32 v32, v32, v32
    v_lshlrev_b32 v32, 16, v32
    ds_write_b32 v66, v32 offset:2048
    s_waitcnt lgkmcnt(0)
    s_barrier
    s_cmp_lg_u32 s98, 392
    s_cbranch_scc1 L_noep
    v_mov_b32 v7, s6
    s_mov_b64 exec, 1
    buffer_store_dword v7, v79, s[16:19], 0 offen sc1
    s_mov_b64 exec, -1
L_noep:
    s_cmp_ge_u32 s3, 4
    s_cbranch_scc1 L_b4
    ds_read_b32 v108, v79 offset:2048
    ds_read_b128 v[96:99], v68 offset:2048
    ds_read_b128 v[100:103], v68 offset:2064
    ds_read_b32 v104, v69 offset:2048
    s_waitcnt lgkmcnt(1)
    v_pk_add_f32 v[112:113], v[96:97], v[108:109] op_sel_hi:[1,0] neg_lo:[0,1] neg_hi:[0,1]
    v_pk_add_f32 v[114:115], v[98:99], v[108:109] op_sel_hi:[1,0] neg_lo:[0,1] neg_hi:[0,1]
    v_pk_add_f32 v[116:117], v[100:101], v[108:109] op_sel_hi:[1,0] neg_lo:[0,1] neg_hi:[0,1]
    v_pk_add_f32 v[118:119], v[102:103], v[108:109] op_sel_hi:[1,0] neg_lo:[0,1] neg_hi:[0,1]
    v_pk_add_f32 v[16:17], v[112:113], v[114:115]
    v_pk_mul_f32 v[18:19], v[112:113], v[112:113]
    v_pk_add_f32 v[28:29], v[116:117], v[118:119]
    v_pk_mul_f32 v[30:31], v[116:117], v[116:117]
    v_pk_fma_f32 v[18:19], v[114:115], v[114:115], v[18:19]
    v_pk_fma_f32 v[30:31], v[118:119], v[118:119], v[30:31]
    v_pk_add_f32 v[16:17], v[16:17], v[28:29]
    v_pk_add_f32 v[18:19], v[18:19], v[30:31]
    s_nop 1
    v_permlane16_swap_b32 v16, v18
    v_permlane16_swap_b32 v17, v19
    v_pk_add_f32 v[16:17], v[16:17], v[18:19]
    v_add_f32 v16, v16, v17
    v_mov_b32 v18, v16
    s_nop 1
    v_permlane32_swap_b32 v16, v18
    v_add_f32 v16, v16, v18
    s_nop 1
    v_add_f32_dpp v16, v16, v16 row_ror:1 row_mask:0xf bank_mask:0xf
    s_nop 1
    v_add_f32_dpp v16, v16, v16 row_ror:2 row_mask:0xf bank_mask:0xf
    s_nop 1
    v_add_f32_dpp v16, v16, v16 row_ror:4 row_mask:0xf bank_mask:0xf
    s_nop 1
    v_add_f32_dpp v16, v16, v16 row_ror:8 row_mask:0xf bank_mask:0xf
    v_mul_f32 v16, 0x3b000000, v16
    v_mov_b32 v18, v16
    s_nop 1
    v_permlane16_swap_b32 v16, v18
    v_fma_f32 v18, -v16, v16, v18
    v_add_f32 v16, v16, v108
    v_max_f32 v18, 0, v18
    v_cvt_pk_bf16_f32 v28, v16, v18
    v_and_b32 v18, 0xffff0000, v28
    v_lshlrev_b32 v16, 16, v28
    v_add_f32 v18, 0x3727c5ac, v18
    v_pk_add_f32 v[96:97], v[96:97], v[16:17] op_sel_hi:[1,0] neg_lo:[0,1] neg_hi:[0,1]
    v_cvt_pk_bf16_f32 v18, v18, v18
    v_pk_add_f32 v[98:99], v[98:99], v[16:17] op_sel_hi:[1,0] neg_lo:[0,1] neg_hi:[0,1]
    v_lshlrev_b32 v18, 16, v18
    v_pk_add_f32 v[100:101], v[100:101], v[16:17] op_sel_hi:[1,0] neg_lo:[0,1] neg_hi:[0,1]
    v_sqrt_f32 v18, v18
    v_pk_add_f32 v[102:103], v[102:103], v[16:17] op_sel_hi:[1,0] neg_lo:[0,1] neg_hi:[0,1]
    v_pk_mul_f32 v[96:97], v[96:97], v[192:193]
    v_cvt_pk_bf16_f32 v18, v18, v18
    v_pk_mul_f32 v[98:99], v[98:99], v[194:195]
    v_lshlrev_b32 v18, 16, v18
    v_pk_mul_f32 v[100:101], v[100:101], v[196:197]
    v_rcp_f32 v18, v18
    v_pk_mul_f32 v[102:103], v[102:103], v[198:199]
    v_pk_fma_f32 v[96:97], v[96:97], v[18:19], v[200:201] op_sel_hi:[1,0,1]
    v_pk_fma_f32 v[98:99], v[98:99], v[18:19], v[202:203] op_sel_hi:[1,0,1]
    v_pk_fma_f32 v[100:101], v[100:101], v[18:19], v[204:205] op_sel_hi:[1,0,1]
    v_pk_fma_f32 v[102:103], v[102:103], v[18:19], v[206:207] op_sel_hi:[1,0,1]
    v_cvt_pk_bf16_f32 v208, v96, v97
    v_cvt_pk_bf16_f32 v209, v98, v99
    v_cvt_pk_bf16_f32 v210, v100, v101
    v_cvt_pk_bf16_f32 v211, v102, v103
    s_nop 1
    v_mfma_f32_16x16x32_bf16 v[32:35], v[208:211], v[160:163], 0
    v_mfma_f32_16x16x32_bf16 v[48:51], v[208:211], v[176:179], 0
    v_mfma_f32_16x16x32_bf16 v[36:39], v[208:211], v[164:167], 0
    v_mfma_f32_16x16x32_bf16 v[52:55], v[208:211], v[180:183], 0
    v_mfma_f32_16x16x32_bf16 v[40:43], v[208:211], v[168:171], 0
    v_mfma_f32_16x16x32_bf16 v[56:59], v[208:211], v[184:187], 0
    v_mfma_f32_16x16x32_bf16 v[44:47], v[208:211], v[172:175], 0
    v_mfma_f32_16x16x32_bf16 v[60:63], v[208:211], v[188:191], 0
    s_mov_b64 exec, 0xffff
    s_nop 1
    v_add_f32 v32, v32, v37
    v_add_f32 v48, v48, v53
    v_add_f32 v32, v32, v42
    v_add_f32 v48, v48, v58
    v_add_f32 v32, v32, v47
    v_add_f32 v48, v48, v63
    ds_write2st64_b32 v75, v32, v48 offset0:16 offset1:17
    s_mov_b64 exec, -1
    s_waitcnt lgkmcnt(0)
L_b4:
    v_mov_b32 v28, 0
    v_mov_b32 v29, 0
    s_barrier
    ds_read_b128 v[32:35], v74 offset:4096
    ds_read_b128 v[40:43], v74 offset:4112
    s_waitcnt lgkmcnt(0)
    v_pk_add_f32 v[32:33], v[32:33], v[34:35]
    v_pk_add_f32 v[40:41], v[40:41], v[42:43]
    v_add_f32 v32, v32, v33
    v_add_f32 v40, v40, v41
    v_max_f32 v32, 0, v32
    v_max_f32 v40, 0, v40
    v_cvt_pk_bf16_f32 v32, v32, v40
    s_nop 1
    v_dot2c_f32_bf16_dpp v28, v32, v144 row_newbcast:0 row_mask:0xf bank_mask:0xf
    v_dot2c_f32_bf16_dpp v29, v32, v145 row_newbcast:1 row_mask:0xf bank_mask:0xf
    v_dot2c_f32_bf16_dpp v28, v32, v146 row_newbcast:2 row_mask:0xf bank_mask:0xf
    v_dot2c_f32_bf16_dpp v29, v32, v147 row_newbcast:3 row_mask:0xf bank_mask:0xf
    v_dot2c_f32_bf16_dpp v28, v32, v148 row_newbcast:4 row_mask:0xf bank_mask:0xf
    v_dot2c_f32_bf16_dpp v29, v32, v149 row_newbcast:5 row_mask:0xf bank_mask:0xf
    v_dot2c_f32_bf16_dpp v28, v32, v150 row_newbcast:6 row_mask:0xf bank_mask:0xf
    v_dot2c_f32_bf16_dpp v29, v32, v151 row_newbcast:7 row_mask:0xf bank_mask:0xf
    v_dot2c_f32_bf16_dpp v28, v32, v152 row_newbcast:8 row_mask:0xf bank_mask:0xf
    v_dot2c_f32_bf16_dpp v29, v32, v153 row_newbcast:9 row_mask:0xf bank_mask:0xf
    v_dot2c_f32_bf16_dpp v28, v32, v154 row_newbcast:10 row_mask:0xf bank_mask:0xf
    v_dot2c_f32_bf16_dpp v29, v32, v155 row_newbcast:11 row_mask:0xf bank_mask:0xf
    v_dot2c_f32_bf16_dpp v28, v32, v156 row_newbcast:12 row_mask:0xf bank_mask:0xf
    v_dot2c_f32_bf16_dpp v29, v32, v157 row_newbcast:13 row_mask:0xf bank_mask:0xf
    v_dot2c_f32_bf16_dpp v28, v32, v158 row_newbcast:14 row_mask:0xf bank_mask:0xf
    v_dot2c_f32_bf16_dpp v29, v32, v159 row_newbcast:15 row_mask:0xf bank_mask:0xf
    s_nop 2
    v_add_f32 v28, v28, v29
    v_min_u32 v28, -2, v28
    buffer_store_dword v28, v73, s[16:19], s42 offen sc1
    s_cmp_ge_u32 s98, 128
    s_cbranch_scc1 L_fin
    v_lshlrev_b32 v77, 11, v1
    s_add_u32 s101, s99, 393216
    v_mov_b32 v48, 0
    v_mov_b32 v49, 0
    v_mov_b32 v50, 0
    v_mov_b32 v51, 0
    s_waitcnt vmcnt(0)
    s_mov_b32 s7, 0x40000
    s_mov_b32 exec_hi, 0xffffff
    buffer_load_dwordx4 v[48:51], v77, s[16:19], s101 offen sc1
    s_mov_b64 exec, -1
    s_lshl_b32 s83, s98, 3
    v_mov_b32 v6, 0
    v_mov_b32 v7, s6
    v_lshlrev_b32 v28, 1, v64
    s_nop 1
L_pollc:
    s_waitcnt vmcnt(0)
    v_max3_u32 v30, v48, v49, v50
    v_max_u32 v30, v30, v51
    v_cmp_eq_u32 vcc, -1, v30
    s_nop 0
    s_cbranch_vccz L_gotc
    s_mov_b64 exec, vcc
    buffer_load_dwordx4 v[48:51], v77, s[16:19], s101 offen sc1
    s_mov_b64 exec, -1
    s_sub_u32 s7, s7, 1
    s_cbranch_scc0 L_pollc
    s_branch L_end
L_gotc:
    v_permlane16_swap_b32 v48, v49
    v_permlane16_swap_b32 v50, v51
    v_add_f32 v48, v48, v49
    v_add_f32 v50, v50, v51
    s_nop 1
    v_permlane32_swap_b32 v48, v50
    v_add_f32 v48, v48, v50
    s_nop 1
    v_add_f32_dpp v48, v48, v48 row_ror:1 row_mask:0xf bank_mask:0xf
    s_nop 1
    v_add_f32_dpp v48, v48, v48 row_ror:2 row_mask:0xf bank_mask:0xf
    s_nop 1
    v_add_f32_dpp v48, v48, v48 row_ror:4 row_mask:0xf bank_mask:0xf
    s_nop 1
    v_add_f32_dpp v48, v48, v48 row_ror:8 row_mask:0xf bank_mask:0xf
    v_cvt_pk_bf16_f32 v48, v48, v48
    v_lshlrev_b32 v48, 16, v48
    v_mul_f32 v48, v48, v224
    v_cvt_pk_bf16_f32 v48, v48, v48
    v_lshlrev_b32 v48, 16, v48
    v_add_f32 v48, v48, v104
    v_cvt_pk_bf16_f32 v48, v48, v48
    s_mov_b32 exec_lo, 0x10001
    s_mov_b32 exec_hi, 0x10001
    buffer_store_short v48, v28, s[36:39], s83 offen
L_fin:
L_end:
    s_endpgm
.section .rodata,"a"
.p2align 6
.amdhsa_kernel adaLN_cond__gqa_block_cached__dense_activation_relu__decode_kernel
  .amdhsa_next_free_vgpr 256
  .amdhsa_next_free_sgpr 102
  .amdhsa_accum_offset 256
  .amdhsa_group_segment_fixed_size 0
  .amdhsa_kernarg_size 104
  .amdhsa_user_sgpr_count 2
  .amdhsa_user_sgpr_kernarg_segment_ptr 1
  .amdhsa_system_sgpr_workgroup_id_x 1
  .amdhsa_float_denorm_mode_32 3
.end_amdhsa_kernel
```
